```python
import torch

def _softmax(x, axis=-1):
    return torch.softmax(x, dim=axis)
def _gelu(x):
    return torch.nn.functional.gelu(x, approximate="tanh")
def _silu(x):
    return torch.nn.functional.silu(x)
def _sigmoid(x):
    return torch.sigmoid(x)
def _layernorm(x, axis=-1, eps=1e-5):
    m = x.mean(dim=axis, keepdim=True)
    v = x.var(dim=axis, keepdim=True, unbiased=False)
    return (x - m) / torch.sqrt(v + eps)
def _scatter_add(tgt, idx, src, axis=0):
    return tgt.clone().index_add_(axis, idx, src)
def _segment_sum(src, seg, n):
    out = torch.zeros((n,) + src.shape[1:], dtype=src.dtype)
    return out.index_add_(0, seg, src)
def _pad(x, pw):
    flat = tuple(v for pair in reversed(pw) for v in pair)
    return torch.nn.functional.pad(x, flat)

kernel_name = 'sequential_preLN__ssm_conv_s4__glu_gated_bilinear__prompt'

def setup_inputs():

    _w = (lambda a: (lambda t: t.to(torch.bfloat16) if t.is_floating_point() else t)(torch.as_tensor(a)))
    def _A_setup():
        B, L, D, N = 1, 2048, 448, 256
        A_re = -(lambda _x: torch.exp(torch.as_tensor(_x)))((lambda *s: torch.randn(*s, dtype=torch.bfloat16) * 3.2)(D, N))
        A_im = torch.pi * (lambda *s: torch.randn(*s, dtype=torch.bfloat16) * 0.05)(D, N)
        B_re = (lambda *s: torch.randn(*s, dtype=torch.bfloat16) * 0.05)(D, N)
        B_im = (lambda *s: torch.randn(*s, dtype=torch.bfloat16) * 0.05)(D, N)
        C_re = (lambda *s: torch.randn(*s, dtype=torch.bfloat16) * 0.05)(D, N)
        C_im = (lambda *s: torch.randn(*s, dtype=torch.bfloat16) * 0.05)(D, N)
        log_dt = (lambda *s: torch.randn(*s, dtype=torch.bfloat16) * 0.05)(D) * 0.5 - 4.0
        Dskip = (lambda *s: torch.randn(*s, dtype=torch.bfloat16) * 0.05)(D)
        return {
            "u": _w((lambda *s: torch.randn(*s, dtype=torch.bfloat16) * 0.05)(B, L, D)),
            "A_re": _w(A_re),
            "A_im": _w(A_im),
            "B_re": _w(B_re),
            "B_im": _w(B_im),
            "C_re": _w(C_re),
            "C_im": _w(C_im),
            "log_dt": _w(log_dt),
            "Dskip": _w(Dskip),
        }
    _A_in = _A_setup()

    def _B_setup():
        B, S, D, F = 1, 2048, 448, 1792
        return {
            "x": _w((lambda *s: torch.randn(*s, dtype=torch.bfloat16) * 0.05)(B, S, D)),
            "w_gate": _w((lambda *s: torch.randn(*s, dtype=torch.bfloat16) * 0.4)(D, F) * (D ** -0.5)),
            "w_up": _w((lambda *s: torch.randn(*s, dtype=torch.bfloat16) * 0.4)(D, F) * (D ** -0.5)),
            "w_down": _w((lambda *s: torch.randn(*s, dtype=torch.bfloat16) * 0.4)(F, D) * (F ** -0.5)),
        }
    _B_in = _B_setup()

    return {
        "A_u": _A_in["u"],
        "A_A_re": _A_in["A_re"],
        "A_A_im": _A_in["A_im"],
        "A_B_re": _A_in["B_re"],
        "A_B_im": _A_in["B_im"],
        "A_C_re": _A_in["C_re"],
        "A_C_im": _A_in["C_im"],
        "A_log_dt": _A_in["log_dt"],
        "A_Dskip": _A_in["Dskip"],
        "B_x": _B_in["x"],
        "B_w_gate": _B_in["w_gate"],
        "B_w_up": _B_in["w_up"],
        "B_w_down": _B_in["w_down"],
    }

def reference(A_u, A_A_re, A_A_im, A_B_re, A_B_im, A_C_re, A_C_im, A_log_dt, A_Dskip, B_x, B_w_gate, B_w_up, B_w_down):
    def _A_ref(u, A_re, A_im, B_re, B_im, C_re, C_im, log_dt, Dskip):
        Bsz, L, D = u.shape
        dt = torch.exp(log_dt)[:, None]
        A = A_re + 1j * A_im
        Bc = B_re + 1j * B_im
        Cc = C_re + 1j * C_im
        logdA = dt * A
        dB = dt * Bc
        l = (lambda x, dt: x.to(dt))(torch.arange(L), A_re.dtype)
        P = torch.exp(logdA[:, :, None] * l[None, None, :])
        K = torch.einsum("dn,dnl,dn->dl", Cc, P, dB).real
        L2 = 2 * L
        Kp = _pad(K, ((0, 0), (0, L)))
        up = (lambda x, *d: x.permute(*d))(u, 0, 2, 1)
        up = _pad(up, ((0, 0), (0, 0), (0, L)))
        Kf = (lambda x, axes=(-2,-1): torch.fft.rfft2(x.float(), dim=axes))(Kp[:, None, :], axes=(-2, -1))
        Uf = (lambda x, axes=(-2,-1): torch.fft.rfft2(x.float(), dim=axes))(up[:, :, None, :], axes=(-2, -1))
        Yf = Uf * Kf[None, :, :, :]
        y = (lambda x, s, axes=(-2,-1): torch.fft.irfft2(x, s=s, dim=axes).to(torch.bfloat16))(Yf, (1, L2), axes=(-2, -1))[:, :, 0, :L]
        y = (lambda x, *d: x.permute(*d))(y, 0, 2, 1) + u * Dskip[None, None, :]
        return y

    def _B_ref(x, w_gate, w_up, w_down):
        g = torch.einsum("bsd,df->bsf", x, w_gate)
        u = torch.einsum("bsd,df->bsf", x, w_up)
        h = g * u
        return torch.einsum("bsf,fd->bsd", h, w_down)

    x = A_u
    h = x + _A_ref(_layernorm(x, axis=-1), A_A_re, A_A_im, A_B_re, A_B_im, A_C_re, A_C_im, A_log_dt, A_Dskip)
    h2 = h + _B_ref(_layernorm(h, axis=-1), B_w_gate, B_w_up, B_w_down)
    return h2
```

```asm
; @launch kernel=k12_kernel grid=(256,1,1) block=(576,1,1) lds=151936
; @launch kernel=k34_kernel grid=(224,1,1) block=(448,1,1) lds=163840
.amdgcn_target "amdgcn-amd-amdhsa--gfx950"
.text
    .globl k12_kernel
    .p2align 8
    .type k12_kernel,@function
k12_kernel:
    s_cmp_ge_u32 s2, 256
    s_cbranch_scc1 k12_end
    v_lshrrev_b32 v1, 6, v0
    v_and_b32 v2, 63, v0
    v_readfirstlane_b32 s34, v1
    v_subrev_u32 v0, 64, v0
    s_nop 2
    s_cmp_lg_u32 s34, 0
    s_cbranch_scc1 k12_notln

k12_ln:
    s_setprio 3
    s_load_dwordx2 s[4:5], s[0:1], 0
    s_load_dwordx2 s[8:9], s[0:1], 120
    v_and_b32 v3, 15, v2
    v_lshrrev_b32 v4, 4, v2
    v_mul_u32_u24 v6, 896, v4
    v_lshl_add_u32 v6, v3, 4, v6
    v_add_u32 v7, 3584, v6
    v_mov_b32 v40, 0
    v_mov_b32 v41, 0
    v_mov_b32 v42, 0
    v_mov_b32 v43, 0
    v_mov_b32 v44, 0
    v_mov_b32 v45, 0
    v_mov_b32 v46, 0
    v_mov_b32 v47, 0
    v_cmp_gt_u32 vcc, 8, v3
    s_mov_b64 s[36:37], vcc
    s_mul_i32 s13, s2, 7168
    s_mov_b32 s6, 1835008
    s_mov_b32 s7, 0x20000
    s_mov_b32 s10, 0x800000
    s_mov_b32 s11, 0x20000
    v_mov_b32 v61, 32768
    s_waitcnt lgkmcnt(0)
    buffer_load_dword v61, v61, s[8:11], 0 offen sc1

    buffer_load_dwordx4 v[16:19], v6, s[4:7], s13 offen offset:0
    buffer_load_dwordx4 v[20:23], v7, s[4:7], s13 offen offset:0
    buffer_load_dwordx4 v[24:27], v6, s[4:7], s13 offen offset:256
    buffer_load_dwordx4 v[28:31], v7, s[4:7], s13 offen offset:256
    buffer_load_dwordx4 v[32:35], v6, s[4:7], s13 offen offset:512
    buffer_load_dwordx4 v[36:39], v7, s[4:7], s13 offen offset:512
    s_mov_b64 exec, s[36:37]
    buffer_load_dwordx4 v[40:43], v6, s[4:7], s13 offen offset:768
    buffer_load_dwordx4 v[44:47], v7, s[4:7], s13 offen offset:768
    s_mov_b64 exec, -1
    v_lshrrev_b32 v49, 2, v3
    v_and_b32 v50, 3, v3
    v_and_b32 v51, 1, v49
    v_lshlrev_b32 v51, 4, v51
    v_mov_b32 v52, 0x3f80
    v_lshlrev_b32 v52, v51, v52
    v_cmp_eq_u32 vcc, v50, v4
    s_nop 1
    v_cndmask_b32 v52, 0, v52, vcc
    v_cmp_gt_u32 vcc, 2, v49
    s_nop 1
    v_cndmask_b32 v8, 0, v52, vcc
    v_sub_u32 v9, v52, v8
    v_mov_b32 v10, 0
    v_mov_b32 v11, 0
    v_mov_b32 v12, v8
    v_mov_b32 v13, v9
    s_mov_b32 s15, 0xffff0000
    v_mov_b32 v96, 0
    v_mov_b32 v97, 0
    v_mov_b32 v98, 0
    v_mov_b32 v99, 0
    v_mov_b32 v100, 0
    v_mov_b32 v101, 0
    v_mov_b32 v102, 0
    v_mov_b32 v103, 0
    v_lshrrev_b32 v14, 2, v3
    v_lshlrev_b32 v14, 10, v14
    v_lshl_add_u32 v14, v4, 7, v14
    v_and_b32 v15, 3, v3
    v_lshl_add_u32 v14, v15, 4, v14
    s_mul_i32 s16, s2, 14336
    s_add_u32 s16, s16, 2097152
    v_mov_b32 v62, 1380
    s_waitcnt vmcnt(8)
    v_add_u32 v61, 2654435769, v61
    ds_write_b32 v62, v61

    v_mov_b32 v105, v61
    v_mov_b32 v107, v61
    v_mov_b32 v109, v61
    v_mov_b32 v111, v61
    v_mov_b32 v113, v61
    v_mov_b32 v115, v61
    v_mov_b32 v117, v61
    v_mov_b32 v119, v61
    v_mov_b32 v121, v61
    v_mov_b32 v123, v61
    v_mov_b32 v125, v61
    v_mov_b32 v127, v61
    v_mov_b32 v129, v61
    v_mov_b32 v131, v61
    v_mov_b32 v133, v61
    v_mov_b32 v135, v61
    s_waitcnt lgkmcnt(0)
    s_barrier
    s_waitcnt vmcnt(6)
    v_mfma_f32_16x16x32_bf16 v[64:67], v[8:11], v[16:19], 0
    v_mfma_f32_16x16x32_bf16 v[68:71], v[8:11], v[20:23], 0
    v_mfma_f32_16x16x32_bf16 v[72:75], v[10:13], v[16:19], 0
    v_mfma_f32_16x16x32_bf16 v[76:79], v[10:13], v[20:23], 0
    s_waitcnt vmcnt(4)
    v_mfma_f32_16x16x32_bf16 v[80:83], v[8:11], v[24:27], 0
    v_mfma_f32_16x16x32_bf16 v[84:87], v[8:11], v[28:31], 0
    v_mfma_f32_16x16x32_bf16 v[88:91], v[10:13], v[24:27], 0
    v_mfma_f32_16x16x32_bf16 v[92:95], v[10:13], v[28:31], 0
    v_cvt_pk_bf16_f32 v104, v64, v65
    v_cvt_pk_bf16_f32 v106, v66, v67
    v_cvt_pk_bf16_f32 v108, v68, v69
    v_cvt_pk_bf16_f32 v110, v70, v71
    buffer_store_dwordx4 v[104:107], v14, s[8:11], s16 offen offset:0 sc1
    buffer_store_dwordx4 v[108:111], v14, s[8:11], s16 offen offset:64 sc1
    v_cvt_pk_bf16_f32 v112, v72, v73
    v_cvt_pk_bf16_f32 v114, v74, v75
    v_cvt_pk_bf16_f32 v116, v76, v77
    v_cvt_pk_bf16_f32 v118, v78, v79
    buffer_store_dwordx4 v[112:115], v14, s[8:11], s16 offen offset:512 sc1
    buffer_store_dwordx4 v[116:119], v14, s[8:11], s16 offen offset:576 sc1
    s_add_u32 s16, s16, 4096
    s_waitcnt vmcnt(6)
    v_mfma_f32_16x16x32_bf16 v[64:67], v[8:11], v[32:35], 0
    v_mfma_f32_16x16x32_bf16 v[68:71], v[8:11], v[36:39], 0
    v_mfma_f32_16x16x32_bf16 v[72:75], v[10:13], v[32:35], 0
    v_mfma_f32_16x16x32_bf16 v[76:79], v[10:13], v[36:39], 0
    v_cvt_pk_bf16_f32 v120, v80, v81
    v_cvt_pk_bf16_f32 v122, v82, v83
    v_cvt_pk_bf16_f32 v124, v84, v85
    v_cvt_pk_bf16_f32 v126, v86, v87
    buffer_store_dwordx4 v[120:123], v14, s[8:11], s16 offen offset:0 sc1
    buffer_store_dwordx4 v[124:127], v14, s[8:11], s16 offen offset:64 sc1
    v_cvt_pk_bf16_f32 v128, v88, v89
    v_cvt_pk_bf16_f32 v130, v90, v91
    v_cvt_pk_bf16_f32 v132, v92, v93
    v_cvt_pk_bf16_f32 v134, v94, v95
    buffer_store_dwordx4 v[128:131], v14, s[8:11], s16 offen offset:512 sc1
    buffer_store_dwordx4 v[132:135], v14, s[8:11], s16 offen offset:576 sc1
    s_add_u32 s16, s16, 4096
    s_waitcnt vmcnt(8)
    v_mfma_f32_16x16x32_bf16 v[80:83], v[8:11], v[40:43], 0
    v_mfma_f32_16x16x32_bf16 v[84:87], v[8:11], v[44:47], 0
    v_mfma_f32_16x16x32_bf16 v[88:91], v[10:13], v[40:43], 0
    v_mfma_f32_16x16x32_bf16 v[92:95], v[10:13], v[44:47], 0
    v_cvt_pk_bf16_f32 v104, v64, v65
    v_cvt_pk_bf16_f32 v106, v66, v67
    v_cvt_pk_bf16_f32 v108, v68, v69
    v_cvt_pk_bf16_f32 v110, v70, v71
    buffer_store_dwordx4 v[104:107], v14, s[8:11], s16 offen offset:0 sc1
    buffer_store_dwordx4 v[108:111], v14, s[8:11], s16 offen offset:64 sc1
    v_cvt_pk_bf16_f32 v112, v72, v73
    v_cvt_pk_bf16_f32 v114, v74, v75
    v_cvt_pk_bf16_f32 v116, v76, v77
    v_cvt_pk_bf16_f32 v118, v78, v79
    buffer_store_dwordx4 v[112:115], v14, s[8:11], s16 offen offset:512 sc1
    buffer_store_dwordx4 v[116:119], v14, s[8:11], s16 offen offset:576 sc1
    s_add_u32 s16, s16, 4096
    s_nop 4
    s_mov_b64 exec, s[36:37]
    v_cvt_pk_bf16_f32 v120, v80, v81
    v_cvt_pk_bf16_f32 v122, v82, v83
    v_cvt_pk_bf16_f32 v124, v84, v85
    v_cvt_pk_bf16_f32 v126, v86, v87
    buffer_store_dwordx4 v[120:123], v14, s[8:11], s16 offen offset:0 sc1
    buffer_store_dwordx4 v[124:127], v14, s[8:11], s16 offen offset:64 sc1
    v_cvt_pk_bf16_f32 v128, v88, v89
    v_cvt_pk_bf16_f32 v130, v90, v91
    v_cvt_pk_bf16_f32 v132, v92, v93
    v_cvt_pk_bf16_f32 v134, v94, v95
    buffer_store_dwordx4 v[128:131], v14, s[8:11], s16 offen offset:512 sc1
    buffer_store_dwordx4 v[132:135], v14, s[8:11], s16 offen offset:576 sc1
    s_add_u32 s16, s16, 4096
    s_mov_b64 exec, -1
    v_lshlrev_b32 v56, 16, v16
    v_and_b32 v57, s15, v16
    v_pk_add_f32 v[96:97], v[96:97], v[56:57]
    v_pk_fma_f32 v[98:99], v[56:57], v[56:57], v[98:99]
    v_lshlrev_b32 v58, 16, v17
    v_and_b32 v59, s15, v17
    v_pk_add_f32 v[96:97], v[96:97], v[58:59]
    v_pk_fma_f32 v[98:99], v[58:59], v[58:59], v[98:99]
    v_lshlrev_b32 v56, 16, v18
    v_and_b32 v57, s15, v18
    v_pk_add_f32 v[96:97], v[96:97], v[56:57]
    v_pk_fma_f32 v[98:99], v[56:57], v[56:57], v[98:99]
    v_lshlrev_b32 v58, 16, v19
    v_and_b32 v59, s15, v19
    v_pk_add_f32 v[96:97], v[96:97], v[58:59]
    v_pk_fma_f32 v[98:99], v[58:59], v[58:59], v[98:99]
    v_lshlrev_b32 v56, 16, v20
    v_and_b32 v57, s15, v20
    v_pk_add_f32 v[100:101], v[100:101], v[56:57]
    v_pk_fma_f32 v[102:103], v[56:57], v[56:57], v[102:103]
    v_lshlrev_b32 v58, 16, v21
    v_and_b32 v59, s15, v21
    v_pk_add_f32 v[100:101], v[100:101], v[58:59]
    v_pk_fma_f32 v[102:103], v[58:59], v[58:59], v[102:103]
    v_lshlrev_b32 v56, 16, v22
    v_and_b32 v57, s15, v22
    v_pk_add_f32 v[100:101], v[100:101], v[56:57]
    v_pk_fma_f32 v[102:103], v[56:57], v[56:57], v[102:103]
    v_lshlrev_b32 v58, 16, v23
    v_and_b32 v59, s15, v23
    v_pk_add_f32 v[100:101], v[100:101], v[58:59]
    v_pk_fma_f32 v[102:103], v[58:59], v[58:59], v[102:103]
    v_lshlrev_b32 v56, 16, v24
    v_and_b32 v57, s15, v24
    v_pk_add_f32 v[96:97], v[96:97], v[56:57]
    v_pk_fma_f32 v[98:99], v[56:57], v[56:57], v[98:99]
    v_lshlrev_b32 v58, 16, v25
    v_and_b32 v59, s15, v25
    v_pk_add_f32 v[96:97], v[96:97], v[58:59]
    v_pk_fma_f32 v[98:99], v[58:59], v[58:59], v[98:99]
    v_lshlrev_b32 v56, 16, v26
    v_and_b32 v57, s15, v26
    v_pk_add_f32 v[96:97], v[96:97], v[56:57]
    v_pk_fma_f32 v[98:99], v[56:57], v[56:57], v[98:99]
    v_lshlrev_b32 v58, 16, v27
    v_and_b32 v59, s15, v27
    v_pk_add_f32 v[96:97], v[96:97], v[58:59]
    v_pk_fma_f32 v[98:99], v[58:59], v[58:59], v[98:99]
    v_lshlrev_b32 v56, 16, v28
    v_and_b32 v57, s15, v28
    v_pk_add_f32 v[100:101], v[100:101], v[56:57]
    v_pk_fma_f32 v[102:103], v[56:57], v[56:57], v[102:103]
    v_lshlrev_b32 v58, 16, v29
    v_and_b32 v59, s15, v29
    v_pk_add_f32 v[100:101], v[100:101], v[58:59]
    v_pk_fma_f32 v[102:103], v[58:59], v[58:59], v[102:103]
    v_lshlrev_b32 v56, 16, v30
    v_and_b32 v57, s15, v30
    v_pk_add_f32 v[100:101], v[100:101], v[56:57]
    v_pk_fma_f32 v[102:103], v[56:57], v[56:57], v[102:103]
    v_lshlrev_b32 v58, 16, v31
    v_and_b32 v59, s15, v31
    v_pk_add_f32 v[100:101], v[100:101], v[58:59]
    v_pk_fma_f32 v[102:103], v[58:59], v[58:59], v[102:103]
    v_lshlrev_b32 v56, 16, v32
    v_and_b32 v57, s15, v32
    v_pk_add_f32 v[96:97], v[96:97], v[56:57]
    v_pk_fma_f32 v[98:99], v[56:57], v[56:57], v[98:99]
    v_lshlrev_b32 v58, 16, v33
    v_and_b32 v59, s15, v33
    v_pk_add_f32 v[96:97], v[96:97], v[58:59]
    v_pk_fma_f32 v[98:99], v[58:59], v[58:59], v[98:99]
    v_lshlrev_b32 v56, 16, v34
    v_and_b32 v57, s15, v34
    v_pk_add_f32 v[96:97], v[96:97], v[56:57]
    v_pk_fma_f32 v[98:99], v[56:57], v[56:57], v[98:99]
    v_lshlrev_b32 v58, 16, v35
    v_and_b32 v59, s15, v35
    v_pk_add_f32 v[96:97], v[96:97], v[58:59]
    v_pk_fma_f32 v[98:99], v[58:59], v[58:59], v[98:99]
    v_lshlrev_b32 v56, 16, v36
    v_and_b32 v57, s15, v36
    v_pk_add_f32 v[100:101], v[100:101], v[56:57]
    v_pk_fma_f32 v[102:103], v[56:57], v[56:57], v[102:103]
    v_lshlrev_b32 v58, 16, v37
    v_and_b32 v59, s15, v37
    v_pk_add_f32 v[100:101], v[100:101], v[58:59]
    v_pk_fma_f32 v[102:103], v[58:59], v[58:59], v[102:103]
    v_lshlrev_b32 v56, 16, v38
    v_and_b32 v57, s15, v38
    v_pk_add_f32 v[100:101], v[100:101], v[56:57]
    v_pk_fma_f32 v[102:103], v[56:57], v[56:57], v[102:103]
    v_lshlrev_b32 v58, 16, v39
    v_and_b32 v59, s15, v39
    v_pk_add_f32 v[100:101], v[100:101], v[58:59]
    v_pk_fma_f32 v[102:103], v[58:59], v[58:59], v[102:103]
    v_lshlrev_b32 v56, 16, v40
    v_and_b32 v57, s15, v40
    v_pk_add_f32 v[96:97], v[96:97], v[56:57]
    v_pk_fma_f32 v[98:99], v[56:57], v[56:57], v[98:99]
    v_lshlrev_b32 v58, 16, v41
    v_and_b32 v59, s15, v41
    v_pk_add_f32 v[96:97], v[96:97], v[58:59]
    v_pk_fma_f32 v[98:99], v[58:59], v[58:59], v[98:99]
    v_lshlrev_b32 v56, 16, v42
    v_and_b32 v57, s15, v42
    v_pk_add_f32 v[96:97], v[96:97], v[56:57]
    v_pk_fma_f32 v[98:99], v[56:57], v[56:57], v[98:99]
    v_lshlrev_b32 v58, 16, v43
    v_and_b32 v59, s15, v43
    v_pk_add_f32 v[96:97], v[96:97], v[58:59]
    v_pk_fma_f32 v[98:99], v[58:59], v[58:59], v[98:99]
    v_lshlrev_b32 v56, 16, v44
    v_and_b32 v57, s15, v44
    v_pk_add_f32 v[100:101], v[100:101], v[56:57]
    v_pk_fma_f32 v[102:103], v[56:57], v[56:57], v[102:103]
    v_lshlrev_b32 v58, 16, v45
    v_and_b32 v59, s15, v45
    v_pk_add_f32 v[100:101], v[100:101], v[58:59]
    v_pk_fma_f32 v[102:103], v[58:59], v[58:59], v[102:103]
    v_lshlrev_b32 v56, 16, v46
    v_and_b32 v57, s15, v46
    v_pk_add_f32 v[100:101], v[100:101], v[56:57]
    v_pk_fma_f32 v[102:103], v[56:57], v[56:57], v[102:103]
    v_lshlrev_b32 v58, 16, v47
    v_and_b32 v59, s15, v47
    v_pk_add_f32 v[100:101], v[100:101], v[58:59]
    v_pk_fma_f32 v[102:103], v[58:59], v[58:59], v[102:103]
    v_add_f32 v48, v96, v97
    v_add_f32 v49, v98, v99
    v_add_f32 v50, v100, v101
    v_add_f32 v51, v102, v103
    s_nop 1
    v_add_f32_dpp v48, v48, v48 row_ror:8 row_mask:0xf bank_mask:0xf
    v_add_f32_dpp v49, v49, v49 row_ror:8 row_mask:0xf bank_mask:0xf
    v_add_f32_dpp v50, v50, v50 row_ror:8 row_mask:0xf bank_mask:0xf
    v_add_f32_dpp v51, v51, v51 row_ror:8 row_mask:0xf bank_mask:0xf
    s_nop 1
    v_add_f32_dpp v48, v48, v48 row_ror:4 row_mask:0xf bank_mask:0xf
    v_add_f32_dpp v49, v49, v49 row_ror:4 row_mask:0xf bank_mask:0xf
    v_add_f32_dpp v50, v50, v50 row_ror:4 row_mask:0xf bank_mask:0xf
    v_add_f32_dpp v51, v51, v51 row_ror:4 row_mask:0xf bank_mask:0xf
    s_nop 1
    v_add_f32_dpp v48, v48, v48 row_ror:2 row_mask:0xf bank_mask:0xf
    v_add_f32_dpp v49, v49, v49 row_ror:2 row_mask:0xf bank_mask:0xf
    v_add_f32_dpp v50, v50, v50 row_ror:2 row_mask:0xf bank_mask:0xf
    v_add_f32_dpp v51, v51, v51 row_ror:2 row_mask:0xf bank_mask:0xf
    s_nop 1
    v_add_f32_dpp v48, v48, v48 row_ror:1 row_mask:0xf bank_mask:0xf
    v_add_f32_dpp v49, v49, v49 row_ror:1 row_mask:0xf bank_mask:0xf
    v_add_f32_dpp v50, v50, v50 row_ror:1 row_mask:0xf bank_mask:0xf
    v_add_f32_dpp v51, v51, v51 row_ror:1 row_mask:0xf bank_mask:0xf
    v_mul_f32 v48, 0x3b124925, v48
    v_mul_f32 v49, 0x3b124925, v49
    v_fma_f32 v49, -v48, v48, v49
    v_max_f32 v49, 0, v49
    v_cvt_pk_bf16_f32 v49, v49, v49
    v_and_b32 v49, s15, v49
    v_add_f32 v49, 0x3727c5ac, v49
    v_cvt_pk_bf16_f32 v49, v49, v49
    v_and_b32 v49, s15, v49
    v_sqrt_f32 v49, v49
    s_nop 0
    v_cvt_pk_bf16_f32 v48, v48, v49

    v_mul_f32 v50, 0x3b124925, v50
    v_mul_f32 v51, 0x3b124925, v51
    v_fma_f32 v51, -v50, v50, v51
    v_max_f32 v51, 0, v51
    v_cvt_pk_bf16_f32 v51, v51, v51
    v_and_b32 v51, s15, v51
    v_add_f32 v51, 0x3727c5ac, v51
    v_cvt_pk_bf16_f32 v51, v51, v51
    v_and_b32 v51, s15, v51
    v_sqrt_f32 v51, v51
    s_nop 0
    v_cvt_pk_bf16_f32 v50, v50, v51

    s_lshl_b32 s12, s2, 6
    v_lshlrev_b32 v60, 14, v3
    v_lshl_add_u32 v60, v4, 4, v60
    v_add_u32 v60, s12, v60
    v_mov_b32 v52, v48
    v_mov_b32 v53, v61
    v_mov_b32 v54, v50
    v_mov_b32 v55, v61
    s_mov_b32 s12, 65536
    buffer_store_dwordx4 v[52:55], v60, s[8:11], s12 offen sc1

    v_add_u32 v0, 64, v0
    s_endpgm
k12_notln:
    s_getpc_b64 s[26:27]
k12_pc0:
    s_add_u32 s26, s26, k12_kernel-k12_pc0
    s_addc_u32 s27, s27, -1
    s_cmp_lg_u32 s34, 1
    s_cbranch_scc1 k12_nocp
    v_lshlrev_b32 v5, 7, v2
    v_min_u32 v5, k12_tab1-k12_kernel-4, v5
    global_load_dword v160, v5, s[26:27]
    v_add_u32 v5, 8192, v5
    v_min_u32 v5, k12_tab1-k12_kernel-4, v5
    global_load_dword v161, v5, s[26:27]
k12_nocp:
    s_sub_u32 s34, s34, 1
    s_lshr_b32 s35, s34, 2
    s_mul_i32 s35, s35, 1408
    s_and_b32 s36, s34, 3
    s_lshl_b32 s36, s36, 2
    s_add_u32 s35, s35, s36
    s_add_u32 s60, s35, 1392
    v_mov_b32 v3, s60
    v_mov_b32 v4, 0
    ds_write_b32 v3, v4
    s_cmp_ge_u32 s2, 224
    s_cbranch_scc1 k12_cs

    s_load_dwordx16 s[4:19], s[0:1], 8
    s_load_dwordx4 s[20:23], s[0:1], 112
    s_and_b32 s33, s2, 7
    s_mul_i32 s33, s33, 28
    s_lshr_b32 s35, s2, 3
    s_add_u32 s33, s33, s35
    s_getpc_b64 s[26:27]
k12_pc:
    s_add_u32 s26, s26, k12_tab1-k12_pc
    s_addc_u32 s27, s27, 0
    v_and_b32 v60, 255, v0
    s_add_u32 s28, s26, 4096
    s_addc_u32 s29, s27, 0
    s_lshr_b32 s3, s33, 4
    s_lshl_b32 s3, s3, 5
    s_and_b32 s35, s33, 1
    s_lshl_b32 s35, s35, 4
    s_add_u32 s3, s3, s35
    s_bfe_u32 s35, s33, 0x30001
    s_add_u32 s3, s3, s35
    s_lshr_b32 s36, s34, 2
    s_lshl_b32 s35, s36, 3
    s_add_u32 s3, s3, s35
    s_and_b32 s37, s34, 3

    s_lshl_b32 s24, s3, 9
    v_lshlrev_b32 v1, 1, v60
    v_add_u32 v1, s24, v1
    s_lshr_b32 s25, s3, 1
    s_lshl_b32 s25, s25, 2
    s_mul_i32 s38, s36, 57664
    s_add_u32 s38, s38, 2816
    s_mul_i32 s39, s37, 14416
    s_add_u32 s39, s39, s38
    v_lshlrev_b32 v3, 2, v2
    v_add_u32 v3, s39, v3
    s_waitcnt lgkmcnt(0)
    s_load_dword s24, s[16:17], s25
    s_load_dword s40, s[18:19], s25
    s_mov_b32 s52, s22
    s_mov_b32 s53, s23
    s_mov_b32 s54, 0x800000
    s_mov_b32 s55, 0x20000
    s_mov_b32 s56, s20
    s_mov_b32 s57, s21
    s_mov_b32 s58, 256
    s_mov_b32 s59, 0x20000
    global_load_short_d16_hi v16, v1, s[4:5]
    global_load_short_d16_hi v17, v1, s[6:7]
    global_load_short_d16_hi v18, v1, s[8:9]
    global_load_short_d16_hi v19, v1, s[10:11]
    global_load_short_d16_hi v20, v1, s[12:13]
    global_load_short_d16_hi v21, v1, s[14:15]
    v_lshlrev_b32 v46, 4, v60
    v_lshlrev_b32 v47, 5, v60
    global_load_dwordx4 v[4:7], v46, s[26:27]
    global_load_dwordx4 v[8:11], v47, s[28:29]
    global_load_dwordx4 v[12:15], v47, s[28:29] offset:16
    global_load_dwordx4 v[128:131], v47, s[28:29] offset:32
    global_load_dwordx4 v[132:135], v47, s[28:29] offset:48
    v_mov_b32 v48, 0
    v_mov_b32 v49, 0
    v_mov_b32 v50, 0
    v_mov_b32 v51, 0
    s_mul_i32 s41, s36, 4608
    s_add_u32 s41, s41, 118144
    v_lshlrev_b32 v52, 4, v2
    v_add_u32 v52, s41, v52
    s_mul_i32 s42, s36, 1408
    s_add_u32 s42, s42, 1376
    v_mov_b32 v53, s42
    v_cmp_gt_u32 vcc, 30, v2
    s_cmp_lg_u32 s37, 0
    s_cbranch_scc1 k12_nopad
    s_and_saveexec_b64 s[30:31], vcc
    ds_write_b128 v52, v[48:51]
    ds_write_b32 v53, v48
    s_mov_b64 exec, s[30:31]
k12_nopad:
    s_waitcnt lgkmcnt(0)
    s_lshl_b32 s43, s24, 16
    s_and_b32 s25, s24, 0xffff0000
    s_bitcmp1_b32 s3, 0
    s_cselect_b32 s24, s25, s43
    s_lshl_b32 s43, s40, 16
    s_and_b32 s25, s40, 0xffff0000
    s_bitcmp1_b32 s3, 0
    s_cselect_b32 s40, s25, s43
    v_mov_b32 v22, s24
    v_mul_f32 v22, 0x3fb8aa3b, v22
    v_exp_f32 v22, v22
    s_nop 0
    v_cvt_pk_bf16_f32 v22, v22, v22
    v_and_b32 v22, 0xffff0000, v22
    s_barrier
    s_waitcnt vmcnt(9)
    v_mul_f32 v23, v22, v16
    v_mul_f32 v24, v22, v17
    v_mul_f32 v23, 0x3fb8aa3b, v23
    v_mul_f32 v24, 0x3e22f983, v24

    v_mul_f32 v46, 0x41000000, v23
    v_mul_f32 v48, 0x41000000, v24
    v_fract_f32 v48, v48
    v_exp_f32 v46, v46
    v_cos_f32 v30, v48
    v_sin_f32 v31, v48
    s_nop 0
    v_pk_mul_f32 v[30:31], v[30:31], v[46:47] op_sel_hi:[1,0]
    v_mov_b32 v46, v23
    v_fract_f32 v48, v24
    v_exp_f32 v46, v46
    v_cos_f32 v28, v48
    v_sin_f32 v29, v48
    s_nop 0
    v_pk_mul_f32 v[28:29], v[28:29], v[46:47] op_sel_hi:[1,0]
    v_mul_f32 v46, 0x43800000, v23
    v_mul_f32 v48, 0x43800000, v24
    v_fract_f32 v48, v48
    v_exp_f32 v46, v46
    v_cos_f32 v32, v48
    v_sin_f32 v33, v48
    s_nop 0
    v_pk_mul_f32 v[32:33], v[32:33], v[46:47] op_sel_hi:[1,0]
    v_mov_b32 v56, 0x3f80
    ds_write_b32 v3, v56 offset:5712
    v_cvt_pk_bf16_f32 v52, v30, v31
    ds_write_b32 v3, v52 offset:5984
    v_pk_mul_f32 v[38:39], v[30:31], v[30:31] op_sel_hi:[1,0]
    v_pk_fma_f32 v[38:39], v[30:31], v[30:31], v[38:39] op_sel:[1,1,0] op_sel_hi:[0,1,1] neg_lo:[1,0,0]
    v_cvt_pk_bf16_f32 v53, v38, v39
    ds_write_b32 v3, v53 offset:6256
    v_pk_mul_f32 v[40:41], v[38:39], v[30:31] op_sel_hi:[1,0]
    v_pk_fma_f32 v[40:41], v[38:39], v[30:31], v[40:41] op_sel:[1,1,0] op_sel_hi:[0,1,1] neg_lo:[1,0,0]
    v_cvt_pk_bf16_f32 v54, v40, v41
    ds_write_b32 v3, v54 offset:6528
    v_pk_mul_f32 v[38:39], v[40:41], v[30:31] op_sel_hi:[1,0]
    v_pk_fma_f32 v[38:39], v[40:41], v[30:31], v[38:39] op_sel:[1,1,0] op_sel_hi:[0,1,1] neg_lo:[1,0,0]
    v_cvt_pk_bf16_f32 v55, v38, v39
    ds_write_b32 v3, v55 offset:6800
    v_pk_mul_f32 v[40:41], v[38:39], v[30:31] op_sel_hi:[1,0]
    v_pk_fma_f32 v[40:41], v[38:39], v[30:31], v[40:41] op_sel:[1,1,0] op_sel_hi:[0,1,1] neg_lo:[1,0,0]
    v_cvt_pk_bf16_f32 v52, v40, v41
    ds_write_b32 v3, v52 offset:7072
    v_pk_mul_f32 v[38:39], v[40:41], v[30:31] op_sel_hi:[1,0]
    v_pk_fma_f32 v[38:39], v[40:41], v[30:31], v[38:39] op_sel:[1,1,0] op_sel_hi:[0,1,1] neg_lo:[1,0,0]
    v_cvt_pk_bf16_f32 v53, v38, v39
    ds_write_b32 v3, v53 offset:7344
    v_pk_mul_f32 v[40:41], v[38:39], v[30:31] op_sel_hi:[1,0]
    v_pk_fma_f32 v[40:41], v[38:39], v[30:31], v[40:41] op_sel:[1,1,0] op_sel_hi:[0,1,1] neg_lo:[1,0,0]
    v_cvt_pk_bf16_f32 v54, v40, v41
    ds_write_b32 v3, v54 offset:7616
    v_pk_mul_f32 v[38:39], v[40:41], v[30:31] op_sel_hi:[1,0]
    v_pk_fma_f32 v[38:39], v[40:41], v[30:31], v[38:39] op_sel:[1,1,0] op_sel_hi:[0,1,1] neg_lo:[1,0,0]
    v_cvt_pk_bf16_f32 v55, v38, v39
    ds_write_b32 v3, v55 offset:7888
    v_pk_mul_f32 v[40:41], v[38:39], v[30:31] op_sel_hi:[1,0]
    v_pk_fma_f32 v[40:41], v[38:39], v[30:31], v[40:41] op_sel:[1,1,0] op_sel_hi:[0,1,1] neg_lo:[1,0,0]
    v_cvt_pk_bf16_f32 v52, v40, v41
    ds_write_b32 v3, v52 offset:8160
    v_pk_mul_f32 v[38:39], v[40:41], v[30:31] op_sel_hi:[1,0]
    v_pk_fma_f32 v[38:39], v[40:41], v[30:31], v[38:39] op_sel:[1,1,0] op_sel_hi:[0,1,1] neg_lo:[1,0,0]
    v_cvt_pk_bf16_f32 v53, v38, v39
    ds_write_b32 v3, v53 offset:8432
    v_pk_mul_f32 v[40:41], v[38:39], v[30:31] op_sel_hi:[1,0]
    v_pk_fma_f32 v[40:41], v[38:39], v[30:31], v[40:41] op_sel:[1,1,0] op_sel_hi:[0,1,1] neg_lo:[1,0,0]
    v_cvt_pk_bf16_f32 v54, v40, v41
    ds_write_b32 v3, v54 offset:8704
    v_pk_mul_f32 v[38:39], v[40:41], v[30:31] op_sel_hi:[1,0]
    v_pk_fma_f32 v[38:39], v[40:41], v[30:31], v[38:39] op_sel:[1,1,0] op_sel_hi:[0,1,1] neg_lo:[1,0,0]
    v_cvt_pk_bf16_f32 v55, v38, v39
    ds_write_b32 v3, v55 offset:8976
    v_pk_mul_f32 v[40:41], v[38:39], v[30:31] op_sel_hi:[1,0]
    v_pk_fma_f32 v[40:41], v[38:39], v[30:31], v[40:41] op_sel:[1,1,0] op_sel_hi:[0,1,1] neg_lo:[1,0,0]
    v_cvt_pk_bf16_f32 v52, v40, v41
    ds_write_b32 v3, v52 offset:9248
    v_pk_mul_f32 v[38:39], v[40:41], v[30:31] op_sel_hi:[1,0]
    v_pk_fma_f32 v[38:39], v[40:41], v[30:31], v[38:39] op_sel:[1,1,0] op_sel_hi:[0,1,1] neg_lo:[1,0,0]
    v_cvt_pk_bf16_f32 v53, v38, v39
    ds_write_b32 v3, v53 offset:9520
    v_pk_mul_f32 v[40:41], v[38:39], v[30:31] op_sel_hi:[1,0]
    v_pk_fma_f32 v[40:41], v[38:39], v[30:31], v[40:41] op_sel:[1,1,0] op_sel_hi:[0,1,1] neg_lo:[1,0,0]
    v_cvt_pk_bf16_f32 v54, v40, v41
    ds_write_b32 v3, v54 offset:9792
    v_pk_mul_f32 v[38:39], v[40:41], v[30:31] op_sel_hi:[1,0]
    v_pk_fma_f32 v[38:39], v[40:41], v[30:31], v[38:39] op_sel:[1,1,0] op_sel_hi:[0,1,1] neg_lo:[1,0,0]
    v_cvt_pk_bf16_f32 v55, v38, v39
    ds_write_b32 v3, v55 offset:10064
    v_pk_mul_f32 v[40:41], v[38:39], v[30:31] op_sel_hi:[1,0]
    v_pk_fma_f32 v[40:41], v[38:39], v[30:31], v[40:41] op_sel:[1,1,0] op_sel_hi:[0,1,1] neg_lo:[1,0,0]
    v_cvt_pk_bf16_f32 v52, v40, v41
    ds_write_b32 v3, v52 offset:10336
    v_pk_mul_f32 v[38:39], v[40:41], v[30:31] op_sel_hi:[1,0]
    v_pk_fma_f32 v[38:39], v[40:41], v[30:31], v[38:39] op_sel:[1,1,0] op_sel_hi:[0,1,1] neg_lo:[1,0,0]
    v_cvt_pk_bf16_f32 v53, v38, v39
    ds_write_b32 v3, v53 offset:10608
    v_pk_mul_f32 v[40:41], v[38:39], v[30:31] op_sel_hi:[1,0]
    v_pk_fma_f32 v[40:41], v[38:39], v[30:31], v[40:41] op_sel:[1,1,0] op_sel_hi:[0,1,1] neg_lo:[1,0,0]
    v_cvt_pk_bf16_f32 v54, v40, v41
    ds_write_b32 v3, v54 offset:10880
    v_pk_mul_f32 v[38:39], v[40:41], v[30:31] op_sel_hi:[1,0]
    v_pk_fma_f32 v[38:39], v[40:41], v[30:31], v[38:39] op_sel:[1,1,0] op_sel_hi:[0,1,1] neg_lo:[1,0,0]
    v_cvt_pk_bf16_f32 v55, v38, v39
    ds_write_b32 v3, v55 offset:11152
    v_pk_mul_f32 v[40:41], v[38:39], v[30:31] op_sel_hi:[1,0]
    v_pk_fma_f32 v[40:41], v[38:39], v[30:31], v[40:41] op_sel:[1,1,0] op_sel_hi:[0,1,1] neg_lo:[1,0,0]
    v_cvt_pk_bf16_f32 v52, v40, v41
    ds_write_b32 v3, v52 offset:11424
    v_pk_mul_f32 v[38:39], v[40:41], v[30:31] op_sel_hi:[1,0]
    v_pk_fma_f32 v[38:39], v[40:41], v[30:31], v[38:39] op_sel:[1,1,0] op_sel_hi:[0,1,1] neg_lo:[1,0,0]
    v_cvt_pk_bf16_f32 v53, v38, v39
    ds_write_b32 v3, v53 offset:11696
    v_pk_mul_f32 v[40:41], v[38:39], v[30:31] op_sel_hi:[1,0]
    v_pk_fma_f32 v[40:41], v[38:39], v[30:31], v[40:41] op_sel:[1,1,0] op_sel_hi:[0,1,1] neg_lo:[1,0,0]
    v_cvt_pk_bf16_f32 v54, v40, v41
    ds_write_b32 v3, v54 offset:11968
    v_pk_mul_f32 v[38:39], v[40:41], v[30:31] op_sel_hi:[1,0]
    v_pk_fma_f32 v[38:39], v[40:41], v[30:31], v[38:39] op_sel:[1,1,0] op_sel_hi:[0,1,1] neg_lo:[1,0,0]
    v_cvt_pk_bf16_f32 v55, v38, v39
    ds_write_b32 v3, v55 offset:12240
    v_pk_mul_f32 v[40:41], v[38:39], v[30:31] op_sel_hi:[1,0]
    v_pk_fma_f32 v[40:41], v[38:39], v[30:31], v[40:41] op_sel:[1,1,0] op_sel_hi:[0,1,1] neg_lo:[1,0,0]
    v_cvt_pk_bf16_f32 v52, v40, v41
    ds_write_b32 v3, v52 offset:12512
    v_pk_mul_f32 v[38:39], v[40:41], v[30:31] op_sel_hi:[1,0]
    v_pk_fma_f32 v[38:39], v[40:41], v[30:31], v[38:39] op_sel:[1,1,0] op_sel_hi:[0,1,1] neg_lo:[1,0,0]
    v_cvt_pk_bf16_f32 v53, v38, v39
    ds_write_b32 v3, v53 offset:12784
    v_pk_mul_f32 v[40:41], v[38:39], v[30:31] op_sel_hi:[1,0]
    v_pk_fma_f32 v[40:41], v[38:39], v[30:31], v[40:41] op_sel:[1,1,0] op_sel_hi:[0,1,1] neg_lo:[1,0,0]
    v_cvt_pk_bf16_f32 v54, v40, v41
    ds_write_b32 v3, v54 offset:13056
    v_pk_mul_f32 v[38:39], v[40:41], v[30:31] op_sel_hi:[1,0]
    v_pk_fma_f32 v[38:39], v[40:41], v[30:31], v[38:39] op_sel:[1,1,0] op_sel_hi:[0,1,1] neg_lo:[1,0,0]
    v_cvt_pk_bf16_f32 v55, v38, v39
    ds_write_b32 v3, v55 offset:13328
    v_pk_mul_f32 v[40:41], v[38:39], v[30:31] op_sel_hi:[1,0]
    v_pk_fma_f32 v[40:41], v[38:39], v[30:31], v[40:41] op_sel:[1,1,0] op_sel_hi:[0,1,1] neg_lo:[1,0,0]
    v_cvt_pk_bf16_f32 v52, v40, v41
    ds_write_b32 v3, v52 offset:13600
    v_pk_mul_f32 v[38:39], v[40:41], v[30:31] op_sel_hi:[1,0]
    v_pk_fma_f32 v[38:39], v[40:41], v[30:31], v[38:39] op_sel:[1,1,0] op_sel_hi:[0,1,1] neg_lo:[1,0,0]
    v_cvt_pk_bf16_f32 v53, v38, v39
    ds_write_b32 v3, v53 offset:13872
    v_pk_mul_f32 v[40:41], v[38:39], v[30:31] op_sel_hi:[1,0]
    v_pk_fma_f32 v[40:41], v[38:39], v[30:31], v[40:41] op_sel:[1,1,0] op_sel_hi:[0,1,1] neg_lo:[1,0,0]
    v_cvt_pk_bf16_f32 v54, v40, v41
    ds_write_b32 v3, v54 offset:14144
    s_waitcnt vmcnt(5)
    v_mul_f32 v18, v22, v18
    v_mul_f32 v19, v22, v19
    v_mul_f32 v26, v20, v18
    v_mul_f32 v27, v20, v19
    v_fma_f32 v26, -v21, v19, v26
    v_fma_f32 v27, v21, v18, v27

    v_cvt_pk_bf16_f32 v55, v26, -v27
    ds_write_b32 v3, v55 offset:0
    v_pk_mul_f32 v[38:39], v[26:27], v[28:29] op_sel_hi:[1,0]
    v_pk_fma_f32 v[38:39], v[26:27], v[28:29], v[38:39] op_sel:[1,1,0] op_sel_hi:[0,1,1] neg_lo:[1,0,0]
    v_cvt_pk_bf16_f32 v52, v38, -v39
    ds_write_b32 v3, v52 offset:272
    v_pk_mul_f32 v[40:41], v[38:39], v[28:29] op_sel_hi:[1,0]
    v_pk_fma_f32 v[40:41], v[38:39], v[28:29], v[40:41] op_sel:[1,1,0] op_sel_hi:[0,1,1] neg_lo:[1,0,0]
    v_cvt_pk_bf16_f32 v53, v40, -v41
    ds_write_b32 v3, v53 offset:544
    v_pk_mul_f32 v[38:39], v[40:41], v[28:29] op_sel_hi:[1,0]
    v_pk_fma_f32 v[38:39], v[40:41], v[28:29], v[38:39] op_sel:[1,1,0] op_sel_hi:[0,1,1] neg_lo:[1,0,0]
    v_cvt_pk_bf16_f32 v54, v38, -v39
    ds_write_b32 v3, v54 offset:816
    v_pk_mul_f32 v[40:41], v[38:39], v[28:29] op_sel_hi:[1,0]
    v_pk_fma_f32 v[40:41], v[38:39], v[28:29], v[40:41] op_sel:[1,1,0] op_sel_hi:[0,1,1] neg_lo:[1,0,0]
    v_cvt_pk_bf16_f32 v55, v40, -v41
    ds_write_b32 v3, v55 offset:1088
    v_pk_mul_f32 v[38:39], v[40:41], v[28:29] op_sel_hi:[1,0]
    v_pk_fma_f32 v[38:39], v[40:41], v[28:29], v[38:39] op_sel:[1,1,0] op_sel_hi:[0,1,1] neg_lo:[1,0,0]
    v_cvt_pk_bf16_f32 v52, v38, -v39
    ds_write_b32 v3, v52 offset:1360
    v_pk_mul_f32 v[40:41], v[38:39], v[28:29] op_sel_hi:[1,0]
    v_pk_fma_f32 v[40:41], v[38:39], v[28:29], v[40:41] op_sel:[1,1,0] op_sel_hi:[0,1,1] neg_lo:[1,0,0]
    v_cvt_pk_bf16_f32 v53, v40, -v41
    ds_write_b32 v3, v53 offset:1632
    v_pk_mul_f32 v[38:39], v[40:41], v[28:29] op_sel_hi:[1,0]
    v_pk_fma_f32 v[38:39], v[40:41], v[28:29], v[38:39] op_sel:[1,1,0] op_sel_hi:[0,1,1] neg_lo:[1,0,0]
    v_cvt_pk_bf16_f32 v54, v38, -v39
    ds_write_b32 v3, v54 offset:1904
    v_pk_mul_f32 v[34:35], v[28:29], v[28:29] op_sel_hi:[1,0]
    v_pk_fma_f32 v[34:35], v[28:29], v[28:29], v[34:35] op_sel:[1,1,0] op_sel_hi:[0,1,1] neg_lo:[1,0,0]
    v_pk_mul_f32 v[36:37], v[34:35], v[34:35] op_sel_hi:[1,0]
    v_pk_fma_f32 v[36:37], v[34:35], v[34:35], v[36:37] op_sel:[1,1,0] op_sel_hi:[0,1,1] neg_lo:[1,0,0]
    v_pk_mul_f32 v[42:43], v[26:27], v[32:33] op_sel_hi:[1,0]
    v_pk_fma_f32 v[42:43], v[26:27], v[32:33], v[42:43] op_sel:[1,1,0] op_sel_hi:[0,1,1] neg_lo:[1,0,0]
    v_cvt_pk_bf16_f32 v55, v42, -v43
    ds_write_b32 v3, v55 offset:2176
    v_pk_mul_f32 v[38:39], v[42:43], v[34:35] op_sel_hi:[1,0]
    v_pk_fma_f32 v[38:39], v[42:43], v[34:35], v[38:39] op_sel:[1,1,0] op_sel_hi:[0,1,1] neg_lo:[1,0,0]
    v_cvt_pk_bf16_f32 v52, v38, -v39
    ds_write_b32 v3, v52 offset:2448
    v_pk_mul_f32 v[40:41], v[38:39], v[34:35] op_sel_hi:[1,0]
    v_pk_fma_f32 v[40:41], v[38:39], v[34:35], v[40:41] op_sel:[1,1,0] op_sel_hi:[0,1,1] neg_lo:[1,0,0]
    v_cvt_pk_bf16_f32 v53, v40, -v41
    ds_write_b32 v3, v53 offset:2720
    v_pk_mul_f32 v[38:39], v[40:41], v[34:35] op_sel_hi:[1,0]
    v_pk_fma_f32 v[38:39], v[40:41], v[34:35], v[38:39] op_sel:[1,1,0] op_sel_hi:[0,1,1] neg_lo:[1,0,0]
    v_cvt_pk_bf16_f32 v54, v38, -v39
    ds_write_b32 v3, v54 offset:2992
    v_pk_mul_f32 v[44:45], v[42:43], v[32:33] op_sel_hi:[1,0]
    v_pk_fma_f32 v[44:45], v[42:43], v[32:33], v[44:45] op_sel:[1,1,0] op_sel_hi:[0,1,1] neg_lo:[1,0,0]
    v_cvt_pk_bf16_f32 v55, v44, -v45
    ds_write_b32 v3, v55 offset:3264
    v_pk_mul_f32 v[38:39], v[44:45], v[36:37] op_sel_hi:[1,0]
    v_pk_fma_f32 v[38:39], v[44:45], v[36:37], v[38:39] op_sel:[1,1,0] op_sel_hi:[0,1,1] neg_lo:[1,0,0]
    v_cvt_pk_bf16_f32 v52, v38, -v39
    ds_write_b32 v3, v52 offset:3536
    v_pk_mul_f32 v[42:43], v[44:45], v[32:33] op_sel_hi:[1,0]
    v_pk_fma_f32 v[42:43], v[44:45], v[32:33], v[42:43] op_sel:[1,1,0] op_sel_hi:[0,1,1] neg_lo:[1,0,0]
    v_cvt_pk_bf16_f32 v53, v42, -v43
    ds_write_b32 v3, v53 offset:3808
    v_pk_mul_f32 v[38:39], v[42:43], v[36:37] op_sel_hi:[1,0]
    v_pk_fma_f32 v[38:39], v[42:43], v[36:37], v[38:39] op_sel:[1,1,0] op_sel_hi:[0,1,1] neg_lo:[1,0,0]
    v_cvt_pk_bf16_f32 v54, v38, -v39
    ds_write_b32 v3, v54 offset:4080
    v_pk_mul_f32 v[44:45], v[42:43], v[32:33] op_sel_hi:[1,0]
    v_pk_fma_f32 v[44:45], v[42:43], v[32:33], v[44:45] op_sel:[1,1,0] op_sel_hi:[0,1,1] neg_lo:[1,0,0]
    v_cvt_pk_bf16_f32 v55, v44, -v45
    ds_write_b32 v3, v55 offset:4352
    v_pk_mul_f32 v[42:43], v[44:45], v[32:33] op_sel_hi:[1,0]
    v_pk_fma_f32 v[42:43], v[44:45], v[32:33], v[42:43] op_sel:[1,1,0] op_sel_hi:[0,1,1] neg_lo:[1,0,0]
    v_cvt_pk_bf16_f32 v52, v42, -v43
    ds_write_b32 v3, v52 offset:4624
    v_pk_mul_f32 v[44:45], v[42:43], v[32:33] op_sel_hi:[1,0]
    v_pk_fma_f32 v[44:45], v[42:43], v[32:33], v[44:45] op_sel:[1,1,0] op_sel_hi:[0,1,1] neg_lo:[1,0,0]
    v_cvt_pk_bf16_f32 v53, v44, -v45
    ds_write_b32 v3, v53 offset:4896
    v_pk_mul_f32 v[42:43], v[44:45], v[32:33] op_sel_hi:[1,0]
    v_pk_fma_f32 v[42:43], v[44:45], v[32:33], v[42:43] op_sel:[1,1,0] op_sel_hi:[0,1,1] neg_lo:[1,0,0]
    v_cvt_pk_bf16_f32 v54, v42, -v43
    ds_write_b32 v3, v54 offset:5168
    v_pk_mul_f32 v[44:45], v[42:43], v[32:33] op_sel_hi:[1,0]
    v_pk_fma_f32 v[44:45], v[42:43], v[32:33], v[44:45] op_sel:[1,1,0] op_sel_hi:[0,1,1] neg_lo:[1,0,0]
    v_cvt_pk_bf16_f32 v55, v44, -v45
    ds_write_b32 v3, v55 offset:5440
    v_and_b32 v61, 31, v2
    s_movk_i32 s30, 272
    v_mul_lo_u32 v62, v61, s30
    v_lshrrev_b32 v59, 5, v2
    v_lshl_add_u32 v62, v59, 4, v62
    v_add_u32 v62, s39, v62
    v_lshlrev_b32 v63, 4, v2
    v_add_u32 v63, s39, v63
    s_waitcnt lgkmcnt(0)

    ds_read_b128 v[64:67], v62 offset:0
    ds_read_b128 v[96:99], v62 offset:5712
    ds_read_b128 v[68:71], v62 offset:32
    ds_read_b128 v[100:103], v62 offset:5744
    ds_read_b128 v[72:75], v62 offset:64
    ds_read_b128 v[104:107], v62 offset:5776
    ds_read_b128 v[76:79], v62 offset:96
    ds_read_b128 v[108:111], v62 offset:5808
    ds_read_b128 v[80:83], v62 offset:128
    ds_read_b128 v[112:115], v62 offset:5840
    ds_read_b128 v[84:87], v62 offset:160
    ds_read_b128 v[116:119], v62 offset:5872
    ds_read_b128 v[88:91], v62 offset:192
    ds_read_b128 v[120:123], v62 offset:5904
    ds_read_b128 v[92:95], v62 offset:224
    ds_read_b128 v[124:127], v62 offset:5936
    s_waitcnt lgkmcnt(14)
    v_mfma_f32_32x32x16_bf16 v[136:151], v[64:67], v[96:99], 0
    s_waitcnt lgkmcnt(12)
    v_mfma_f32_32x32x16_bf16 v[136:151], v[68:71], v[100:103], v[136:151]
    s_waitcnt lgkmcnt(10)
    v_mfma_f32_32x32x16_bf16 v[136:151], v[72:75], v[104:107], v[136:151]
    s_waitcnt lgkmcnt(8)
    v_mfma_f32_32x32x16_bf16 v[136:151], v[76:79], v[108:111], v[136:151]
    s_waitcnt lgkmcnt(6)
    v_mfma_f32_32x32x16_bf16 v[136:151], v[80:83], v[112:115], v[136:151]
    s_waitcnt lgkmcnt(4)
    v_mfma_f32_32x32x16_bf16 v[136:151], v[84:87], v[116:119], v[136:151]
    s_waitcnt lgkmcnt(2)
    v_mfma_f32_32x32x16_bf16 v[136:151], v[88:91], v[120:123], v[136:151]
    s_waitcnt lgkmcnt(0)
    v_mfma_f32_32x32x16_bf16 v[136:151], v[92:95], v[124:127], v[136:151]
    v_lshlrev_b32 v57, 4, v60
    v_add_u32 v57, s38, v57
    v_and_b32 v61, 15, v2
    v_lshrrev_b32 v59, 4, v2
    s_nop 7
    s_nop 3
    ds_write_b128 v63, v[136:139]
    ds_write_b128 v63, v[140:143] offset:1024
    ds_write_b128 v63, v[144:147] offset:2048
    v_mov_b32 v62, s60
    v_mov_b32 v63, 1522786775
    s_mul_i32 s42, s36, 1408
    s_add_u32 s42, s42, 1392
    s_waitcnt lgkmcnt(0)
    ds_write_b32 v62, v63
    v_mov_b32 v62, s42

    s_cmp_eq_u32 s37, 3
    s_cbranch_scc1 k12_tw2
k12_spin:
    ds_read_b128 v[64:67], v62
    s_waitcnt lgkmcnt(0)
    v_xor_b32 v64, v63, v64
    v_xor_b32 v65, v63, v65
    v_xor_b32 v66, v63, v66
    v_xor_b32 v67, v63, v67
    v_or_b32 v64, v64, v65
    v_or3_b32 v64, v64, v66, v67
    v_cmp_ne_u32 vcc, 0, v64
    s_nop 0
    s_cmp_eq_u64 vcc, 0
    s_cbranch_scc0 k12_spin
    ds_read_b128 v[64:67], v57
    ds_read_b128 v[68:71], v57 offset:14416
    ds_read_b128 v[72:75], v57 offset:28832
    ds_read_b128 v[76:79], v57 offset:43248
    s_waitcnt lgkmcnt(2)
    v_pk_add_f32 v[64:65], v[64:65], v[68:69]
    v_pk_add_f32 v[66:67], v[66:67], v[70:71]
    s_waitcnt lgkmcnt(0)
    v_pk_add_f32 v[72:73], v[72:73], v[76:77]
    v_pk_add_f32 v[74:75], v[74:75], v[78:79]
    v_pk_add_f32 v[64:65], v[64:65], v[72:73]
    v_pk_add_f32 v[66:67], v[66:67], v[74:75]
    v_cvt_pk_bf16_f32 v56, v64, v65
    v_cvt_pk_bf16_f32 v58, v66, v67
    s_waitcnt vmcnt(0)
    s_cmp_eq_u32 s36, 0
    s_cbranch_scc0 k12_tw1
    ds_write_b16 v4, v56
    ds_write_b16_d16_hi v5, v56
    ds_write_b16 v6, v58
    ds_write_b16_d16_hi v7, v58
    s_branch k12_tw2
k12_tw1:
    ds_write_b16 v4, v56 offset:1408
    ds_write_b16_d16_hi v5, v56 offset:1408
    ds_write_b16 v6, v58 offset:1408
    ds_write_b16_d16_hi v7, v58 offset:1408
k12_tw2:
    s_waitcnt vmcnt(0)
    v_lshrrev_b32 v59, 4, v2

    v_mov_b32 v66, 1380
    ds_read_b32 v156, v66
    v_lshrrev_b32 v64, 1, v0
    v_mul_u32_u24 v65, 14336, v64
    v_and_b32 v66, 1, v0
    v_lshl_add_u32 v65, v66, 4, v65
    s_lshr_b32 s45, s33, 1
    s_lshl_b32 s45, s45, 7
    s_and_b32 s46, s33, 1
    s_lshl_b32 s46, s46, 5
    s_add_u32 s45, s45, s46
    s_add_u32 s46, s45, 2097152
    v_lshlrev_b32 v67, 6, v64
    s_and_b32 s47, s2, 15
    s_lshl_b32 s47, s47, 14
    s_add_u32 s47, s47, 65536
    v_mul_u32_u24 v68, 4608, v66
    v_lshl_add_u32 v68, v64, 4, v68
    v_add_u32 v68, 118624, v68
    v_lshlrev_b32 v69, 12, v66
    v_lshl_add_u32 v69, v64, 4, v69
    v_add_u32 v69, 127360, v69

    buffer_load_dwordx4 v[72:75], v65, s[52:55], s46 offen sc1
    buffer_load_dwordx4 v[76:79], v65, s[52:55], s46 offen offset:64 sc1
    buffer_load_dwordx4 v[136:139], v67, s[52:55], s47 offen offset:0 sc1
    buffer_load_dwordx4 v[140:143], v67, s[52:55], s47 offen offset:16 sc1
    buffer_load_dwordx4 v[144:147], v67, s[52:55], s47 offen offset:32 sc1
    buffer_load_dwordx4 v[148:151], v67, s[52:55], s47 offen offset:48 sc1
    s_waitcnt lgkmcnt(0)
    s_barrier
    v_mov_b32 v62, s60
    v_mov_b32 v63, 0
    ds_write_b32 v62, v63

    s_cmp_eq_u32 s36, 0
    s_cbranch_scc0 k12_g1
    ds_read_u16 v16, v8 offset:0
    ds_read_u16_d16_hi v24, v9 offset:0
    ds_read_u16 v17, v10 offset:0
    ds_read_u16_d16_hi v25, v11 offset:0
    ds_read_u16 v18, v12 offset:0
    ds_read_u16_d16_hi v26, v13 offset:0
    ds_read_u16 v19, v14 offset:0
    ds_read_u16_d16_hi v27, v15 offset:0
    ds_read_u16 v20, v128 offset:0
    ds_read_u16_d16_hi v28, v129 offset:0
    ds_read_u16 v21, v130 offset:0
    ds_read_u16_d16_hi v29, v131 offset:0
    ds_read_u16 v22, v132 offset:0
    ds_read_u16_d16_hi v30, v133 offset:0
    ds_read_u16 v23, v134 offset:0
    ds_read_u16_d16_hi v31, v135 offset:0
    s_branch k12_g2
k12_g1:
    ds_read_u16 v16, v8 offset:1408
    ds_read_u16_d16_hi v24, v9 offset:1408
    ds_read_u16 v17, v10 offset:1408
    ds_read_u16_d16_hi v25, v11 offset:1408
    ds_read_u16 v18, v12 offset:1408
    ds_read_u16_d16_hi v26, v13 offset:1408
    ds_read_u16 v19, v14 offset:1408
    ds_read_u16_d16_hi v27, v15 offset:1408
    ds_read_u16 v20, v128 offset:1408
    ds_read_u16_d16_hi v28, v129 offset:1408
    ds_read_u16 v21, v130 offset:1408
    ds_read_u16_d16_hi v29, v131 offset:1408
    ds_read_u16 v22, v132 offset:1408
    ds_read_u16_d16_hi v30, v133 offset:1408
    ds_read_u16 v23, v134 offset:1408
    ds_read_u16_d16_hi v31, v135 offset:1408
k12_g2:
    v_lshlrev_b32 v157, 4, v60
    v_add_u32 v157, s38, v157
    v_mul_u32_u24 v158, 4160, v2
    s_add_u32 s45, s38, 4096
    v_add_u32 v158, s45, v158
    v_mov_b32 v48, 0
    v_mov_b32 v49, 0
    v_mov_b32 v50, 0
    v_mov_b32 v51, 0

    s_waitcnt lgkmcnt(14)
    v_or_b32 v16, v16, v24
    s_waitcnt lgkmcnt(12)
    v_or_b32 v17, v17, v25
    s_waitcnt lgkmcnt(10)
    v_or_b32 v18, v18, v26
    s_waitcnt lgkmcnt(8)
    v_or_b32 v19, v19, v27
    s_waitcnt lgkmcnt(6)
    v_or_b32 v20, v20, v28
    s_waitcnt lgkmcnt(4)
    v_or_b32 v21, v21, v29
    s_waitcnt lgkmcnt(2)
    v_or_b32 v22, v22, v30
    s_waitcnt lgkmcnt(0)
    v_or_b32 v23, v23, v31
    v_alignbit_b32 v80, v17, v16, 16
    v_alignbit_b32 v81, v18, v17, 16
    v_alignbit_b32 v82, v19, v18, 16
    v_alignbit_b32 v83, v20, v19, 16
    v_alignbit_b32 v84, v21, v20, 16
    v_alignbit_b32 v85, v22, v21, 16
    v_alignbit_b32 v86, v18, v17, 16
    v_alignbit_b32 v87, v19, v18, 16
    v_alignbit_b32 v88, v20, v19, 16
    v_alignbit_b32 v89, v21, v20, 16
    v_alignbit_b32 v90, v22, v21, 16
    v_alignbit_b32 v91, v23, v22, 16
    v_mov_b32 v92, v17
    v_mov_b32 v93, v18
    v_mov_b32 v94, v19
    v_mov_b32 v95, v20
    v_mov_b32 v96, v21
    v_mov_b32 v97, v22
    ds_write_b128 v157, v[16:19] offset:0
    ds_write_b128 v157, v[80:83] offset:4160
    ds_write_b128 v157, v[92:95] offset:8320
    ds_write_b128 v157, v[86:89] offset:12480
    ds_write_b128 v157, v[18:21] offset:16640
    ds_write_b128 v157, v[82:85] offset:20800
    ds_write_b128 v157, v[94:97] offset:24960
    ds_write_b128 v157, v[88:91] offset:29120
    v_cmp_gt_u32 vcc, 8, v2
    s_cmp_lg_u32 s37, 0
    s_cbranch_scc1 k12_nz
    s_and_saveexec_b64 s[30:31], vcc
    ds_write_b128 v158, v[48:51]
    s_mov_b64 exec, s[30:31]
k12_nz:
    s_mov_b32 s15, 0xffff0000
    s_mov_b32 s44, 100000

k12_chk:
    s_waitcnt vmcnt(0)
    v_xor_b32 v32, v73, v156
    v_xor_b32 v33, v75, v156
    v_xor_b32 v34, v77, v156
    v_xor_b32 v35, v79, v156
    v_or3_b32 v32, v32, v33, v34
    v_xor_b32 v33, v137, v156
    v_xor_b32 v34, v139, v156
    v_or3_b32 v32, v32, v35, v33
    v_xor_b32 v33, v141, v156
    v_xor_b32 v35, v143, v156
    v_or3_b32 v32, v32, v34, v33
    v_xor_b32 v33, v145, v156
    v_xor_b32 v34, v147, v156
    v_or3_b32 v32, v32, v35, v33
    v_xor_b32 v33, v149, v156
    v_xor_b32 v35, v151, v156
    v_or3_b32 v32, v32, v34, v33
    v_or_b32 v32, v32, v35
    v_cmp_ne_u32 vcc, 0, v32
    s_sub_u32 s44, s44, 1
    s_cmp_eq_u64 vcc, 0
    s_cbranch_scc1 k12_chkok
    s_cmp_eq_u32 s44, 0
    s_cbranch_scc1 k12_chkok
    s_sleep 2

    buffer_load_dwordx4 v[72:75], v65, s[52:55], s46 offen sc1
    buffer_load_dwordx4 v[76:79], v65, s[52:55], s46 offen offset:64 sc1
    buffer_load_dwordx4 v[136:139], v67, s[52:55], s47 offen offset:0 sc1
    buffer_load_dwordx4 v[140:143], v67, s[52:55], s47 offen offset:16 sc1
    buffer_load_dwordx4 v[144:147], v67, s[52:55], s47 offen offset:32 sc1
    buffer_load_dwordx4 v[148:151], v67, s[52:55], s47 offen offset:48 sc1
    s_branch k12_chk
k12_chkok:

    v_mov_b32 v32, v72
    v_mov_b32 v33, v74
    v_mov_b32 v34, v76
    v_mov_b32 v35, v78
    ds_write_b128 v69, v[32:35]

    v_and_b32 v110, s15, v136
    v_and_b32 v111, s15, v140
    v_rcp_f32 v110, v110
    v_rcp_f32 v111, v111
    v_lshlrev_b32 v108, 16, v136
    v_lshlrev_b32 v109, 16, v140
    v_lshlrev_b32 v100, 16, v32
    v_and_b32 v101, s15, v32
    v_pk_add_f32 v[100:101], v[100:101], v[108:109] neg_lo:[0,1] neg_hi:[0,1]
    v_cvt_pk_bf16_f32 v100, v100, v101
    v_and_b32 v101, s15, v100
    v_lshlrev_b32 v100, 16, v100
    v_pk_mul_f32 v[100:101], v[100:101], v[110:111]
    v_cvt_pk_bf16_f32 v104, v100, v101
    v_and_b32 v110, s15, v144
    v_and_b32 v111, s15, v148
    v_rcp_f32 v110, v110
    v_rcp_f32 v111, v111
    v_lshlrev_b32 v108, 16, v144
    v_lshlrev_b32 v109, 16, v148
    v_lshlrev_b32 v102, 16, v33
    v_and_b32 v103, s15, v33
    v_pk_add_f32 v[102:103], v[102:103], v[108:109] neg_lo:[0,1] neg_hi:[0,1]
    v_cvt_pk_bf16_f32 v102, v102, v103
    v_and_b32 v103, s15, v102
    v_lshlrev_b32 v102, 16, v102
    v_pk_mul_f32 v[102:103], v[102:103], v[110:111]
    v_cvt_pk_bf16_f32 v105, v102, v103
    v_and_b32 v110, s15, v138
    v_and_b32 v111, s15, v142
    v_rcp_f32 v110, v110
    v_rcp_f32 v111, v111
    v_lshlrev_b32 v108, 16, v138
    v_lshlrev_b32 v109, 16, v142
    v_lshlrev_b32 v100, 16, v34
    v_and_b32 v101, s15, v34
    v_pk_add_f32 v[100:101], v[100:101], v[108:109] neg_lo:[0,1] neg_hi:[0,1]
    v_cvt_pk_bf16_f32 v100, v100, v101
    v_and_b32 v101, s15, v100
    v_lshlrev_b32 v100, 16, v100
    v_pk_mul_f32 v[100:101], v[100:101], v[110:111]
    v_cvt_pk_bf16_f32 v106, v100, v101
    v_and_b32 v110, s15, v146
    v_and_b32 v111, s15, v150
    v_rcp_f32 v110, v110
    v_rcp_f32 v111, v111
    v_lshlrev_b32 v108, 16, v146
    v_lshlrev_b32 v109, 16, v150
    v_lshlrev_b32 v102, 16, v35
    v_and_b32 v103, s15, v35
    v_pk_add_f32 v[102:103], v[102:103], v[108:109] neg_lo:[0,1] neg_hi:[0,1]
    v_cvt_pk_bf16_f32 v102, v102, v103
    v_and_b32 v103, s15, v102
    v_lshlrev_b32 v102, 16, v102
    v_pk_mul_f32 v[102:103], v[102:103], v[110:111]
    v_cvt_pk_bf16_f32 v107, v102, v103
    ds_write_b128 v68, v[104:107]
    s_add_u32 s51, s34, 2
    s_and_b32 s51, s51, 4
    s_waitcnt lgkmcnt(0)
    s_barrier
    s_or_b32 s42, s2, s34
    s_cmp_lg_u32 s42, 0
    s_cbranch_scc1 k12_noep
    v_subrev_u32 v62, 2654435768, v156
    v_mov_b32 v63, 32768
    s_mov_b64 exec, 1
    buffer_store_dword v62, v63, s[52:55], 0 offen sc1
    s_mov_b64 exec, -1
k12_noep:
    s_cmp_lg_u32 s51, 0
    s_cbranch_scc1 k12_inact
    s_and_b32 s50, s34, 1

    v_mov_b32 v96, 0
    v_mov_b32 v97, 0
    v_mov_b32 v98, 0
    v_mov_b32 v99, 0
    v_mov_b32 v100, 0
    v_mov_b32 v101, 0
    v_mov_b32 v102, 0
    v_mov_b32 v103, 0
    v_mov_b32 v104, 0
    v_mov_b32 v105, 0
    v_mov_b32 v106, 0
    v_mov_b32 v107, 0
    v_mov_b32 v108, 0
    v_mov_b32 v109, 0
    v_mov_b32 v110, 0
    v_mov_b32 v111, 0
    v_mov_b32 v112, 0
    v_mov_b32 v113, 0
    v_mov_b32 v114, 0
    v_mov_b32 v115, 0
    v_mov_b32 v116, 0
    v_mov_b32 v117, 0
    v_mov_b32 v118, 0
    v_mov_b32 v119, 0
    v_mov_b32 v120, 0
    v_mov_b32 v121, 0
    v_mov_b32 v122, 0
    v_mov_b32 v123, 0
    v_mov_b32 v124, 0
    v_mov_b32 v125, 0
    v_mov_b32 v126, 0
    v_mov_b32 v127, 0
    v_and_b32 v52, 7, v61
    v_sub_u32 v52, 7, v52
    v_mul_u32_u24 v14, 4160, v52
    v_lshrrev_b32 v52, 3, v61
    v_sub_u32 v52, v59, v52
    v_add_u32 v52, 253, v52
    v_lshl_add_u32 v14, v52, 4, v14
    s_lshl_b32 s45, s50, 8
    s_sub_u32 s30, s38, s45
    s_sub_u32 s30, s30, 3584
    v_add_u32 v14, s30, v14
    v_lshlrev_b32 v15, 5, v61
    v_lshl_add_u32 v15, v59, 4, v15
    s_sub_u32 s30, s41, s45
    s_add_u32 s30, s30, 448
    v_add_u32 v15, s30, v15

    ds_read_b128 v[156:159], v14 offset:0
    ds_read_b128 v[92:95], v15 offset:3584
    ds_read_b128 v[152:155], v14 offset:512
    ds_read_b128 v[88:91], v15 offset:3072
    ds_read_b128 v[148:151], v14 offset:1024
    ds_read_b128 v[84:87], v15 offset:2560
    ds_read_b128 v[144:147], v14 offset:1536
    ds_read_b128 v[80:83], v15 offset:2048
    ds_read_b128 v[140:143], v14 offset:2048
    ds_read_b128 v[76:79], v15 offset:1536
    ds_read_b128 v[136:139], v14 offset:2560
    ds_read_b128 v[72:75], v15 offset:1024
    ds_read_b128 v[132:135], v14 offset:3072
    ds_read_b128 v[68:71], v15 offset:512
    ds_read_b128 v[128:131], v14 offset:3584
    ds_read_b128 v[64:67], v15 offset:0
    s_mov_b32 s45, 4
k12_loop:
    v_subrev_u32 v14, 64, v14
    v_subrev_u32 v15, 64, v15
    s_waitcnt lgkmcnt(6)
    v_mfma_f32_16x16x32_bf16 v[124:127], v[140:143], v[80:83], v[124:127]
    v_mfma_f32_16x16x32_bf16 v[124:127], v[144:147], v[76:79], v[124:127]
    s_waitcnt lgkmcnt(4)
    v_mfma_f32_16x16x32_bf16 v[124:127], v[136:139], v[84:87], v[124:127]
    v_mfma_f32_16x16x32_bf16 v[124:127], v[148:151], v[72:75], v[124:127]
    s_waitcnt lgkmcnt(2)
    v_mfma_f32_16x16x32_bf16 v[124:127], v[132:135], v[88:91], v[124:127]
    v_mfma_f32_16x16x32_bf16 v[124:127], v[152:155], v[68:71], v[124:127]
    s_waitcnt lgkmcnt(0)
    v_mfma_f32_16x16x32_bf16 v[124:127], v[128:131], v[92:95], v[124:127]
    v_mfma_f32_16x16x32_bf16 v[124:127], v[156:159], v[64:67], v[124:127]
    ds_read_b128 v[156:159], v14 offset:0
    ds_read_b128 v[92:95], v15 offset:3584
    v_mfma_f32_16x16x32_bf16 v[120:123], v[128:131], v[88:91], v[120:123]
    v_mfma_f32_16x16x32_bf16 v[120:123], v[132:135], v[84:87], v[120:123]
    v_mfma_f32_16x16x32_bf16 v[120:123], v[136:139], v[80:83], v[120:123]
    v_mfma_f32_16x16x32_bf16 v[120:123], v[140:143], v[76:79], v[120:123]
    v_mfma_f32_16x16x32_bf16 v[120:123], v[144:147], v[72:75], v[120:123]
    v_mfma_f32_16x16x32_bf16 v[120:123], v[148:151], v[68:71], v[120:123]
    v_mfma_f32_16x16x32_bf16 v[120:123], v[152:155], v[64:67], v[120:123]
    ds_read_b128 v[152:155], v14 offset:512
    ds_read_b128 v[88:91], v15 offset:3072
    v_mfma_f32_16x16x32_bf16 v[116:119], v[128:131], v[84:87], v[116:119]
    v_mfma_f32_16x16x32_bf16 v[116:119], v[132:135], v[80:83], v[116:119]
    v_mfma_f32_16x16x32_bf16 v[116:119], v[136:139], v[76:79], v[116:119]
    v_mfma_f32_16x16x32_bf16 v[116:119], v[140:143], v[72:75], v[116:119]
    v_mfma_f32_16x16x32_bf16 v[116:119], v[144:147], v[68:71], v[116:119]
    v_mfma_f32_16x16x32_bf16 v[116:119], v[148:151], v[64:67], v[116:119]
    ds_read_b128 v[148:151], v14 offset:1024
    ds_read_b128 v[84:87], v15 offset:2560
    v_mfma_f32_16x16x32_bf16 v[112:115], v[128:131], v[80:83], v[112:115]
    v_mfma_f32_16x16x32_bf16 v[112:115], v[132:135], v[76:79], v[112:115]
    v_mfma_f32_16x16x32_bf16 v[112:115], v[136:139], v[72:75], v[112:115]
    v_mfma_f32_16x16x32_bf16 v[112:115], v[140:143], v[68:71], v[112:115]
    v_mfma_f32_16x16x32_bf16 v[112:115], v[144:147], v[64:67], v[112:115]
    ds_read_b128 v[144:147], v14 offset:1536
    ds_read_b128 v[80:83], v15 offset:2048
    v_mfma_f32_16x16x32_bf16 v[108:111], v[128:131], v[76:79], v[108:111]
    v_mfma_f32_16x16x32_bf16 v[108:111], v[132:135], v[72:75], v[108:111]
    v_mfma_f32_16x16x32_bf16 v[108:111], v[136:139], v[68:71], v[108:111]
    v_mfma_f32_16x16x32_bf16 v[108:111], v[140:143], v[64:67], v[108:111]
    ds_read_b128 v[140:143], v14 offset:2048
    ds_read_b128 v[76:79], v15 offset:1536
    v_mfma_f32_16x16x32_bf16 v[104:107], v[128:131], v[72:75], v[104:107]
    v_mfma_f32_16x16x32_bf16 v[104:107], v[132:135], v[68:71], v[104:107]
    v_mfma_f32_16x16x32_bf16 v[104:107], v[136:139], v[64:67], v[104:107]
    ds_read_b128 v[136:139], v14 offset:2560
    ds_read_b128 v[72:75], v15 offset:1024
    v_mfma_f32_16x16x32_bf16 v[100:103], v[128:131], v[68:71], v[100:103]
    v_mfma_f32_16x16x32_bf16 v[100:103], v[132:135], v[64:67], v[100:103]
    ds_read_b128 v[132:135], v14 offset:3072
    ds_read_b128 v[68:71], v15 offset:512
    v_mfma_f32_16x16x32_bf16 v[96:99], v[128:131], v[64:67], v[96:99]
    ds_read_b128 v[128:131], v14 offset:3584
    ds_read_b128 v[64:67], v15 offset:0
    s_sub_u32 s45, s45, 1
    s_cmp_lg_u32 s45, 0
    s_cbranch_scc1 k12_loop

    s_waitcnt lgkmcnt(0)
    s_lshl_b32 s45, s36, 1
    s_add_u32 s45, s45, s50
    s_lshl_b32 s30, s45, 12
    s_add_u32 s30, s30, 135552
    v_lshlrev_b32 v13, 4, v2
    v_add_u32 v52, s30, v13
    s_xor_b32 s30, s45, 1
    s_lshl_b32 s30, s30, 12
    s_add_u32 s30, s30, 135552
    v_add_u32 v53, s30, v13
    v_lshlrev_b32 v54, 5, v61
    v_lshl_add_u32 v54, v59, 3, v54
    s_lshl_b32 s45, s50, 11
    s_add_u32 s30, s41, s45
    s_add_u32 s30, s30, 480
    v_add_u32 v55, s30, v54
    s_lshl_b32 s30, s36, 12
    s_add_u32 s30, s30, s45
    s_add_u32 s30, s30, 127360
    v_add_u32 v54, s30, v54
    s_lshl_b32 s30, s3, 8
    s_mul_i32 s45, s50, 917504
    s_add_u32 s30, s30, s45
    s_add_u32 s46, s30, 6291456
    v_lshrrev_b32 v56, 3, v61
    s_mov_b32 s45, 114688
    v_mul_lo_u32 v56, v56, s45
    v_and_b32 v57, 7, v61
    v_lshl_add_u32 v56, v57, 5, v56
    v_lshl_add_u32 v31, v59, 3, v56
    s_cmp_eq_u32 s50, 0
    s_cbranch_scc0 k12_x1

    ds_write_b128 v52, v[112:115] offset:0
    ds_write_b128 v52, v[116:119] offset:1024
    ds_write_b128 v52, v[120:123] offset:2048
    ds_write_b128 v52, v[124:127] offset:3072
    s_waitcnt lgkmcnt(0)
    s_barrier
    ds_read_b128 v[144:147], v53 offset:0
    ds_read_b128 v[148:151], v53 offset:1024
    ds_read_b128 v[152:155], v53 offset:2048
    ds_read_b128 v[156:159], v53 offset:3072
    ds_read_b64 v[32:33], v55 offset:0
    ds_read_b64 v[40:41], v54 offset:0
    ds_read_b64 v[34:35], v55 offset:512
    ds_read_b64 v[42:43], v54 offset:512
    ds_read_b64 v[36:37], v55 offset:1024
    ds_read_b64 v[44:45], v54 offset:1024
    ds_read_b64 v[38:39], v55 offset:1536
    ds_read_b64 v[46:47], v54 offset:1536
    s_waitcnt lgkmcnt(11)
    v_pk_add_f32 v[128:129], v[96:97], v[144:145]
    v_pk_add_f32 v[130:131], v[98:99], v[146:147]
    s_waitcnt lgkmcnt(10)
    v_pk_add_f32 v[132:133], v[100:101], v[148:149]
    v_pk_add_f32 v[134:135], v[102:103], v[150:151]
    s_waitcnt lgkmcnt(9)
    v_pk_add_f32 v[136:137], v[104:105], v[152:153]
    v_pk_add_f32 v[138:139], v[106:107], v[154:155]
    s_waitcnt lgkmcnt(8)
    v_pk_add_f32 v[140:141], v[108:109], v[156:157]
    v_pk_add_f32 v[142:143], v[110:111], v[158:159]
    s_branch k12_x2
k12_x1:
    ds_write_b128 v52, v[96:99] offset:0
    ds_write_b128 v52, v[100:103] offset:1024
    ds_write_b128 v52, v[104:107] offset:2048
    ds_write_b128 v52, v[108:111] offset:3072
    s_waitcnt lgkmcnt(0)
    s_barrier
    ds_read_b128 v[144:147], v53 offset:0
    ds_read_b128 v[148:151], v53 offset:1024
    ds_read_b128 v[152:155], v53 offset:2048
    ds_read_b128 v[156:159], v53 offset:3072
    ds_read_b64 v[32:33], v55 offset:0
    ds_read_b64 v[40:41], v54 offset:0
    ds_read_b64 v[34:35], v55 offset:512
    ds_read_b64 v[42:43], v54 offset:512
    ds_read_b64 v[36:37], v55 offset:1024
    ds_read_b64 v[44:45], v54 offset:1024
    ds_read_b64 v[38:39], v55 offset:1536
    ds_read_b64 v[46:47], v54 offset:1536
    s_waitcnt lgkmcnt(11)
    v_pk_add_f32 v[128:129], v[112:113], v[144:145]
    v_pk_add_f32 v[130:131], v[114:115], v[146:147]
    s_waitcnt lgkmcnt(10)
    v_pk_add_f32 v[132:133], v[116:117], v[148:149]
    v_pk_add_f32 v[134:135], v[118:119], v[150:151]
    s_waitcnt lgkmcnt(9)
    v_pk_add_f32 v[136:137], v[120:121], v[152:153]
    v_pk_add_f32 v[138:139], v[122:123], v[154:155]
    s_waitcnt lgkmcnt(8)
    v_pk_add_f32 v[140:141], v[124:125], v[156:157]
    v_pk_add_f32 v[142:143], v[126:127], v[158:159]
k12_x2:
    s_mov_b32 s24, s40
    s_mov_b32 s25, s40
    s_waitcnt lgkmcnt(0)

    v_lshlrev_b32 v56, 16, v32
    v_and_b32 v57, s15, v32
    v_lshlrev_b32 v58, 16, v33
    v_and_b32 v59, s15, v33
    v_cvt_pk_bf16_f32 v68, v128, v129
    v_cvt_pk_bf16_f32 v69, v130, v131
    v_lshlrev_b32 v128, 16, v68
    v_and_b32 v129, s15, v68
    v_lshlrev_b32 v130, 16, v69
    v_and_b32 v131, s15, v69
    v_pk_mul_f32 v[56:57], v[56:57], s[24:25]
    v_pk_mul_f32 v[58:59], v[58:59], s[24:25]
    v_cvt_pk_bf16_f32 v68, v56, v57
    v_cvt_pk_bf16_f32 v69, v58, v59
    v_lshlrev_b32 v56, 16, v68
    v_and_b32 v57, s15, v68
    v_lshlrev_b32 v58, 16, v69
    v_and_b32 v59, s15, v69
    v_pk_add_f32 v[128:129], v[128:129], v[56:57]
    v_pk_add_f32 v[130:131], v[130:131], v[58:59]
    v_cvt_pk_bf16_f32 v68, v128, v129
    v_cvt_pk_bf16_f32 v69, v130, v131
    v_lshlrev_b32 v128, 16, v68
    v_and_b32 v129, s15, v68
    v_lshlrev_b32 v130, 16, v69
    v_and_b32 v131, s15, v69
    v_lshlrev_b32 v60, 16, v40
    v_and_b32 v61, s15, v40
    v_lshlrev_b32 v62, 16, v41
    v_and_b32 v63, s15, v41
    v_pk_add_f32 v[128:129], v[128:129], v[60:61]
    v_pk_add_f32 v[130:131], v[130:131], v[62:63]
    v_cvt_pk_bf16_f32 v72, v128, v129
    v_cvt_pk_bf16_f32 v73, v130, v131
    buffer_store_dwordx2 v[72:73], v31, s[52:55], s46 offen
    v_add_u32 v31, 229376, v31
    v_lshlrev_b32 v56, 16, v34
    v_and_b32 v57, s15, v34
    v_lshlrev_b32 v58, 16, v35
    v_and_b32 v59, s15, v35
    v_cvt_pk_bf16_f32 v68, v132, v133
    v_cvt_pk_bf16_f32 v69, v134, v135
    v_lshlrev_b32 v132, 16, v68
    v_and_b32 v133, s15, v68
    v_lshlrev_b32 v134, 16, v69
    v_and_b32 v135, s15, v69
    v_pk_mul_f32 v[56:57], v[56:57], s[24:25]
    v_pk_mul_f32 v[58:59], v[58:59], s[24:25]
    v_cvt_pk_bf16_f32 v68, v56, v57
    v_cvt_pk_bf16_f32 v69, v58, v59
    v_lshlrev_b32 v56, 16, v68
    v_and_b32 v57, s15, v68
    v_lshlrev_b32 v58, 16, v69
    v_and_b32 v59, s15, v69
    v_pk_add_f32 v[132:133], v[132:133], v[56:57]
    v_pk_add_f32 v[134:135], v[134:135], v[58:59]
    v_cvt_pk_bf16_f32 v68, v132, v133
    v_cvt_pk_bf16_f32 v69, v134, v135
    v_lshlrev_b32 v132, 16, v68
    v_and_b32 v133, s15, v68
    v_lshlrev_b32 v134, 16, v69
    v_and_b32 v135, s15, v69
    v_lshlrev_b32 v60, 16, v42
    v_and_b32 v61, s15, v42
    v_lshlrev_b32 v62, 16, v43
    v_and_b32 v63, s15, v43
    v_pk_add_f32 v[132:133], v[132:133], v[60:61]
    v_pk_add_f32 v[134:135], v[134:135], v[62:63]
    v_cvt_pk_bf16_f32 v74, v132, v133
    v_cvt_pk_bf16_f32 v75, v134, v135
    buffer_store_dwordx2 v[74:75], v31, s[52:55], s46 offen
    v_add_u32 v31, 229376, v31
    v_lshlrev_b32 v56, 16, v36
    v_and_b32 v57, s15, v36
    v_lshlrev_b32 v58, 16, v37
    v_and_b32 v59, s15, v37
    v_cvt_pk_bf16_f32 v68, v136, v137
    v_cvt_pk_bf16_f32 v69, v138, v139
    v_lshlrev_b32 v136, 16, v68
    v_and_b32 v137, s15, v68
    v_lshlrev_b32 v138, 16, v69
    v_and_b32 v139, s15, v69
    v_pk_mul_f32 v[56:57], v[56:57], s[24:25]
    v_pk_mul_f32 v[58:59], v[58:59], s[24:25]
    v_cvt_pk_bf16_f32 v68, v56, v57
    v_cvt_pk_bf16_f32 v69, v58, v59
    v_lshlrev_b32 v56, 16, v68
    v_and_b32 v57, s15, v68
    v_lshlrev_b32 v58, 16, v69
    v_and_b32 v59, s15, v69
    v_pk_add_f32 v[136:137], v[136:137], v[56:57]
    v_pk_add_f32 v[138:139], v[138:139], v[58:59]
    v_cvt_pk_bf16_f32 v68, v136, v137
    v_cvt_pk_bf16_f32 v69, v138, v139
    v_lshlrev_b32 v136, 16, v68
    v_and_b32 v137, s15, v68
    v_lshlrev_b32 v138, 16, v69
    v_and_b32 v139, s15, v69
    v_lshlrev_b32 v60, 16, v44
    v_and_b32 v61, s15, v44
    v_lshlrev_b32 v62, 16, v45
    v_and_b32 v63, s15, v45
    v_pk_add_f32 v[136:137], v[136:137], v[60:61]
    v_pk_add_f32 v[138:139], v[138:139], v[62:63]
    v_cvt_pk_bf16_f32 v76, v136, v137
    v_cvt_pk_bf16_f32 v77, v138, v139
    buffer_store_dwordx2 v[76:77], v31, s[52:55], s46 offen
    v_add_u32 v31, 229376, v31
    v_lshlrev_b32 v56, 16, v38
    v_and_b32 v57, s15, v38
    v_lshlrev_b32 v58, 16, v39
    v_and_b32 v59, s15, v39
    v_cvt_pk_bf16_f32 v68, v140, v141
    v_cvt_pk_bf16_f32 v69, v142, v143
    v_lshlrev_b32 v140, 16, v68
    v_and_b32 v141, s15, v68
    v_lshlrev_b32 v142, 16, v69
    v_and_b32 v143, s15, v69
    v_pk_mul_f32 v[56:57], v[56:57], s[24:25]
    v_pk_mul_f32 v[58:59], v[58:59], s[24:25]
    v_cvt_pk_bf16_f32 v68, v56, v57
    v_cvt_pk_bf16_f32 v69, v58, v59
    v_lshlrev_b32 v56, 16, v68
    v_and_b32 v57, s15, v68
    v_lshlrev_b32 v58, 16, v69
    v_and_b32 v59, s15, v69
    v_pk_add_f32 v[140:141], v[140:141], v[56:57]
    v_pk_add_f32 v[142:143], v[142:143], v[58:59]
    v_cvt_pk_bf16_f32 v68, v140, v141
    v_cvt_pk_bf16_f32 v69, v142, v143
    v_lshlrev_b32 v140, 16, v68
    v_and_b32 v141, s15, v68
    v_lshlrev_b32 v142, 16, v69
    v_and_b32 v143, s15, v69
    v_lshlrev_b32 v60, 16, v46
    v_and_b32 v61, s15, v46
    v_lshlrev_b32 v62, 16, v47
    v_and_b32 v63, s15, v47
    v_pk_add_f32 v[140:141], v[140:141], v[60:61]
    v_pk_add_f32 v[142:143], v[142:143], v[62:63]
    v_cvt_pk_bf16_f32 v78, v140, v141
    v_cvt_pk_bf16_f32 v79, v142, v143
    buffer_store_dwordx2 v[78:79], v31, s[52:55], s46 offen
    s_endpgm
k12_cs:
    s_cmp_ge_u32 s2, 252
    s_cbranch_scc1 k12_zc
    s_load_dwordx4 s[24:27], s[0:1], 80
    s_load_dwordx2 s[22:23], s[0:1], 120
    s_sub_u32 s3, s2, 224
    s_cmp_ge_u32 s3, 14
    s_cselect_b32 s10, 14, 0
    s_sub_u32 s11, s3, s10
    v_lshrrev_b32 v1, 4, v0
    s_movk_i32 s12, 3584
    v_mul_lo_u32 v2, v1, s12
    v_and_b32 v3, 15, v0
    v_lshl_add_u32 v2, v3, 4, v2
    s_lshl_b32 s13, s11, 8
    v_add_u32 v2, s13, v2
    s_movk_i32 s14, 0x3f80
    s_mov_b32 s15, 0x3f800000
    s_waitcnt lgkmcnt(0)
    s_cmp_ge_u32 s3, 14
    s_cselect_b32 s4, s26, s24
    s_cselect_b32 s5, s27, s25
    s_barrier
    s_barrier

    global_load_dwordx4 v[16:19], v2, s[4:5]
    v_add_u32 v2, 114688, v2
    global_load_dwordx4 v[20:23], v2, s[4:5]
    v_add_u32 v2, 114688, v2
    global_load_dwordx4 v[24:27], v2, s[4:5]
    v_add_u32 v2, 114688, v2
    global_load_dwordx4 v[28:31], v2, s[4:5]
    v_add_u32 v2, 114688, v2
    global_load_dwordx4 v[32:35], v2, s[4:5]
    v_add_u32 v2, 114688, v2
    global_load_dwordx4 v[36:39], v2, s[4:5]
    v_add_u32 v2, 114688, v2
    global_load_dwordx4 v[40:43], v2, s[4:5]
    v_add_u32 v2, 114688, v2
    global_load_dwordx4 v[44:47], v2, s[4:5]
    v_add_u32 v2, 114688, v2
    global_load_dwordx4 v[48:51], v2, s[4:5]
    v_add_u32 v2, 114688, v2
    global_load_dwordx4 v[52:55], v2, s[4:5]
    v_add_u32 v2, 114688, v2
    global_load_dwordx4 v[56:59], v2, s[4:5]
    v_add_u32 v2, 114688, v2
    global_load_dwordx4 v[60:63], v2, s[4:5]
    v_add_u32 v2, 114688, v2
    global_load_dwordx4 v[64:67], v2, s[4:5]
    v_add_u32 v2, 114688, v2
    global_load_dwordx4 v[68:71], v2, s[4:5]
    v_mov_b32 v8, 0
    v_mov_b32 v9, 0
    v_mov_b32 v10, 0
    v_mov_b32 v11, 0
    v_mov_b32 v12, 0
    v_mov_b32 v13, 0
    v_mov_b32 v14, 0
    v_mov_b32 v15, 0
    s_waitcnt vmcnt(13)
    v_dot2c_f32_bf16 v8, s14, v16
    v_dot2c_f32_bf16 v9, s15, v16
    v_dot2c_f32_bf16 v10, s14, v17
    v_dot2c_f32_bf16 v11, s15, v17
    v_dot2c_f32_bf16 v12, s14, v18
    v_dot2c_f32_bf16 v13, s15, v18
    v_dot2c_f32_bf16 v14, s14, v19
    v_dot2c_f32_bf16 v15, s15, v19
    s_waitcnt vmcnt(12)
    v_dot2c_f32_bf16 v8, s14, v20
    v_dot2c_f32_bf16 v9, s15, v20
    v_dot2c_f32_bf16 v10, s14, v21
    v_dot2c_f32_bf16 v11, s15, v21
    v_dot2c_f32_bf16 v12, s14, v22
    v_dot2c_f32_bf16 v13, s15, v22
    v_dot2c_f32_bf16 v14, s14, v23
    v_dot2c_f32_bf16 v15, s15, v23
    s_waitcnt vmcnt(11)
    v_dot2c_f32_bf16 v8, s14, v24
    v_dot2c_f32_bf16 v9, s15, v24
    v_dot2c_f32_bf16 v10, s14, v25
    v_dot2c_f32_bf16 v11, s15, v25
    v_dot2c_f32_bf16 v12, s14, v26
    v_dot2c_f32_bf16 v13, s15, v26
    v_dot2c_f32_bf16 v14, s14, v27
    v_dot2c_f32_bf16 v15, s15, v27
    s_waitcnt vmcnt(10)
    v_dot2c_f32_bf16 v8, s14, v28
    v_dot2c_f32_bf16 v9, s15, v28
    v_dot2c_f32_bf16 v10, s14, v29
    v_dot2c_f32_bf16 v11, s15, v29
    v_dot2c_f32_bf16 v12, s14, v30
    v_dot2c_f32_bf16 v13, s15, v30
    v_dot2c_f32_bf16 v14, s14, v31
    v_dot2c_f32_bf16 v15, s15, v31
    s_waitcnt vmcnt(9)
    v_dot2c_f32_bf16 v8, s14, v32
    v_dot2c_f32_bf16 v9, s15, v32
    v_dot2c_f32_bf16 v10, s14, v33
    v_dot2c_f32_bf16 v11, s15, v33
    v_dot2c_f32_bf16 v12, s14, v34
    v_dot2c_f32_bf16 v13, s15, v34
    v_dot2c_f32_bf16 v14, s14, v35
    v_dot2c_f32_bf16 v15, s15, v35
    s_waitcnt vmcnt(8)
    v_dot2c_f32_bf16 v8, s14, v36
    v_dot2c_f32_bf16 v9, s15, v36
    v_dot2c_f32_bf16 v10, s14, v37
    v_dot2c_f32_bf16 v11, s15, v37
    v_dot2c_f32_bf16 v12, s14, v38
    v_dot2c_f32_bf16 v13, s15, v38
    v_dot2c_f32_bf16 v14, s14, v39
    v_dot2c_f32_bf16 v15, s15, v39
    s_waitcnt vmcnt(7)
    v_dot2c_f32_bf16 v8, s14, v40
    v_dot2c_f32_bf16 v9, s15, v40
    v_dot2c_f32_bf16 v10, s14, v41
    v_dot2c_f32_bf16 v11, s15, v41
    v_dot2c_f32_bf16 v12, s14, v42
    v_dot2c_f32_bf16 v13, s15, v42
    v_dot2c_f32_bf16 v14, s14, v43
    v_dot2c_f32_bf16 v15, s15, v43
    s_waitcnt vmcnt(6)
    v_dot2c_f32_bf16 v8, s14, v44
    v_dot2c_f32_bf16 v9, s15, v44
    v_dot2c_f32_bf16 v10, s14, v45
    v_dot2c_f32_bf16 v11, s15, v45
    v_dot2c_f32_bf16 v12, s14, v46
    v_dot2c_f32_bf16 v13, s15, v46
    v_dot2c_f32_bf16 v14, s14, v47
    v_dot2c_f32_bf16 v15, s15, v47
    s_waitcnt vmcnt(5)
    v_dot2c_f32_bf16 v8, s14, v48
    v_dot2c_f32_bf16 v9, s15, v48
    v_dot2c_f32_bf16 v10, s14, v49
    v_dot2c_f32_bf16 v11, s15, v49
    v_dot2c_f32_bf16 v12, s14, v50
    v_dot2c_f32_bf16 v13, s15, v50
    v_dot2c_f32_bf16 v14, s14, v51
    v_dot2c_f32_bf16 v15, s15, v51
    s_waitcnt vmcnt(4)
    v_dot2c_f32_bf16 v8, s14, v52
    v_dot2c_f32_bf16 v9, s15, v52
    v_dot2c_f32_bf16 v10, s14, v53
    v_dot2c_f32_bf16 v11, s15, v53
    v_dot2c_f32_bf16 v12, s14, v54
    v_dot2c_f32_bf16 v13, s15, v54
    v_dot2c_f32_bf16 v14, s14, v55
    v_dot2c_f32_bf16 v15, s15, v55
    s_waitcnt vmcnt(3)
    v_dot2c_f32_bf16 v8, s14, v56
    v_dot2c_f32_bf16 v9, s15, v56
    v_dot2c_f32_bf16 v10, s14, v57
    v_dot2c_f32_bf16 v11, s15, v57
    v_dot2c_f32_bf16 v12, s14, v58
    v_dot2c_f32_bf16 v13, s15, v58
    v_dot2c_f32_bf16 v14, s14, v59
    v_dot2c_f32_bf16 v15, s15, v59
    s_waitcnt vmcnt(2)
    v_dot2c_f32_bf16 v8, s14, v60
    v_dot2c_f32_bf16 v9, s15, v60
    v_dot2c_f32_bf16 v10, s14, v61
    v_dot2c_f32_bf16 v11, s15, v61
    v_dot2c_f32_bf16 v12, s14, v62
    v_dot2c_f32_bf16 v13, s15, v62
    v_dot2c_f32_bf16 v14, s14, v63
    v_dot2c_f32_bf16 v15, s15, v63
    s_waitcnt vmcnt(1)
    v_dot2c_f32_bf16 v8, s14, v64
    v_dot2c_f32_bf16 v9, s15, v64
    v_dot2c_f32_bf16 v10, s14, v65
    v_dot2c_f32_bf16 v11, s15, v65
    v_dot2c_f32_bf16 v12, s14, v66
    v_dot2c_f32_bf16 v13, s15, v66
    v_dot2c_f32_bf16 v14, s14, v67
    v_dot2c_f32_bf16 v15, s15, v67
    s_waitcnt vmcnt(0)
    v_dot2c_f32_bf16 v8, s14, v68
    v_dot2c_f32_bf16 v9, s15, v68
    v_dot2c_f32_bf16 v10, s14, v69
    v_dot2c_f32_bf16 v11, s15, v69
    v_dot2c_f32_bf16 v12, s14, v70
    v_dot2c_f32_bf16 v13, s15, v70
    v_dot2c_f32_bf16 v14, s14, v71
    v_dot2c_f32_bf16 v15, s15, v71
    v_lshlrev_b32 v4, 9, v1
    v_lshl_add_u32 v4, v3, 5, v4
    s_nop 1
    ds_write_b128 v4, v[8:11]
    ds_write_b128 v4, v[12:15] offset:16
    s_waitcnt lgkmcnt(0)
    s_barrier
    v_cmp_gt_u32 vcc, 128, v0
    s_and_saveexec_b64 s[18:19], vcc
    s_cbranch_execz k12_end
    v_lshlrev_b32 v4, 2, v0

    ds_read_b32 v16, v4 offset:0
    ds_read_b32 v17, v4 offset:512
    ds_read_b32 v18, v4 offset:1024
    ds_read_b32 v19, v4 offset:1536
    ds_read_b32 v20, v4 offset:2048
    ds_read_b32 v21, v4 offset:2560
    ds_read_b32 v22, v4 offset:3072
    ds_read_b32 v23, v4 offset:3584
    ds_read_b32 v24, v4 offset:4096
    ds_read_b32 v25, v4 offset:4608
    ds_read_b32 v26, v4 offset:5120
    ds_read_b32 v27, v4 offset:5632
    ds_read_b32 v28, v4 offset:6144
    ds_read_b32 v29, v4 offset:6656
    ds_read_b32 v30, v4 offset:7168
    ds_read_b32 v31, v4 offset:7680
    s_waitcnt lgkmcnt(0)
    ds_read_b32 v32, v4 offset:8192
    ds_read_b32 v33, v4 offset:8704
    ds_read_b32 v34, v4 offset:9216
    ds_read_b32 v35, v4 offset:9728
    ds_read_b32 v36, v4 offset:10240
    ds_read_b32 v37, v4 offset:10752
    ds_read_b32 v38, v4 offset:11264
    ds_read_b32 v39, v4 offset:11776
    ds_read_b32 v40, v4 offset:12288
    ds_read_b32 v41, v4 offset:12800
    ds_read_b32 v42, v4 offset:13312
    ds_read_b32 v43, v4 offset:13824
    ds_read_b32 v44, v4 offset:14336
    ds_read_b32 v45, v4 offset:14848
    ds_read_b32 v46, v4 offset:15360
    ds_read_b32 v47, v4 offset:15872
    s_waitcnt lgkmcnt(0)
    v_add_f32 v16, v16, v17
    v_add_f32 v16, v16, v18
    v_add_f32 v16, v16, v19
    v_add_f32 v16, v16, v20
    v_add_f32 v16, v16, v21
    v_add_f32 v16, v16, v22
    v_add_f32 v16, v16, v23
    v_add_f32 v16, v16, v24
    v_add_f32 v16, v16, v25
    v_add_f32 v16, v16, v26
    v_add_f32 v16, v16, v27
    v_add_f32 v16, v16, v28
    v_add_f32 v16, v16, v29
    v_add_f32 v16, v16, v30
    v_add_f32 v16, v16, v31
    v_add_f32 v16, v16, v32
    v_add_f32 v16, v16, v33
    v_add_f32 v16, v16, v34
    v_add_f32 v16, v16, v35
    v_add_f32 v16, v16, v36
    v_add_f32 v16, v16, v37
    v_add_f32 v16, v16, v38
    v_add_f32 v16, v16, v39
    v_add_f32 v16, v16, v40
    v_add_f32 v16, v16, v41
    v_add_f32 v16, v16, v42
    v_add_f32 v16, v16, v43
    v_add_f32 v16, v16, v44
    v_add_f32 v16, v16, v45
    v_add_f32 v16, v16, v46
    v_add_f32 v16, v16, v47
    s_lshl_b32 s13, s3, 9
    s_add_u32 s13, s13, 8388608
    s_add_u32 s22, s22, s13
    s_addc_u32 s23, s23, 0
    global_store_dword v4, v16, s[22:23]

    s_endpgm
k12_zc:
    s_cmp_lg_u32 s2, 252
    s_cbranch_scc1 k12_end
    s_cmp_lg_u32 s34, 0
    s_cbranch_scc1 k12_end
    s_load_dwordx2 s[24:25], s[0:1], 120
    v_lshlrev_b32 v1, 7, v2
    v_mov_b32 v3, 0
    s_mov_b32 s26, 0x10000
    s_mov_b32 s27, 0x20000
    s_mov_b32 s28, 0x9000
    s_mov_b64 exec, 0xffff
    s_waitcnt lgkmcnt(0)
    buffer_store_dword v3, v1, s[24:27], s28 offen
    s_endpgm

k12_inact:
    s_cmp_lg_u32 s34, 3
    s_cbranch_scc1 k12_inact2
    s_getpc_b64 s[26:27]
k12_pc1:
    s_add_u32 s26, s26, k34_kernel-k12_pc1
    s_addc_u32 s27, s27, 0
    v_lshlrev_b32 v5, 7, v2
    v_min_u32 v5, k34_end-k34_kernel, v5
    global_load_dword v160, v5, s[26:27]
    v_lshlrev_b32 v5, 7, v2
    v_add_u32 v5, 8192, v5
    v_min_u32 v5, k34_end-k34_kernel, v5
    global_load_dword v161, v5, s[26:27]
    s_endpgm
k12_inact2:
    s_cmp_lg_u32 s34, 2
    s_cbranch_scc1 k12_end
    s_load_dwordx2 s[28:29], s[0:1], 96
    s_mul_i32 s12, s2, 7168
    v_lshlrev_b32 v1, 7, v2
    v_add_u32 v1, s12, v1
    v_cmp_gt_u32 vcc, 56, v2
    s_mov_b32 s30, 1605632
    s_mov_b32 s31, 0x20000
    s_waitcnt lgkmcnt(0)
    s_and_saveexec_b64 s[18:19], vcc
    buffer_load_dword v5, v1, s[28:31], 0 offen

k12_end:
    s_endpgm
.p2align 6
.type k12_tab1,@object
k12_tab1:
    .long 0, 2, 4, 6, 16, 18, 20, 22
    .long 32, 34, 36, 38, 48, 50, 52, 54
    .long 64, 66, 68, 70, 80, 82, 84, 86
    .long 96, 98, 100, 102, 112, 114, 116, 118
    .long 128, 130, 132, 134, 144, 146, 148, 150
    .long 160, 162, 164, 166, 176, 178, 180, 182
    .long 192, 194, 196, 198, 208, 210, 212, 214
    .long 224, 226, 228, 230, 240, 242, 244, 246
    .long 256, 258, 260, 262, 272, 274, 276, 278
    .long 288, 290, 292, 294, 304, 306, 308, 310
    .long 320, 322, 324, 326, 336, 338, 340, 342
    .long 352, 354, 356, 358, 368, 370, 372, 374
    .long 384, 386, 388, 390, 400, 402, 404, 406
    .long 416, 418, 420, 422, 432, 434, 436, 438
    .long 448, 450, 452, 454, 464, 466, 468, 470
    .long 480, 482, 484, 486, 496, 498, 500, 502
    .long 8, 10, 12, 14, 24, 26, 28, 30
    .long 40, 42, 44, 46, 56, 58, 60, 62
    .long 72, 74, 76, 78, 88, 90, 92, 94
    .long 104, 106, 108, 110, 120, 122, 124, 126
    .long 136, 138, 140, 142, 152, 154, 156, 158
    .long 168, 170, 172, 174, 184, 186, 188, 190
    .long 200, 202, 204, 206, 216, 218, 220, 222
    .long 232, 234, 236, 238, 248, 250, 252, 254
    .long 264, 266, 268, 270, 280, 282, 284, 286
    .long 296, 298, 300, 302, 312, 314, 316, 318
    .long 328, 330, 332, 334, 344, 346, 348, 350
    .long 360, 362, 364, 366, 376, 378, 380, 382
    .long 392, 394, 396, 398, 408, 410, 412, 414
    .long 424, 426, 428, 430, 440, 442, 444, 446
    .long 456, 458, 460, 462, 472, 474, 476, 478
    .long 488, 490, 492, 494, 504, 506, 508, 510
    .long 512, 514, 516, 518, 520, 522, 524, 526
    .long 528, 530, 532, 534, 536, 538, 540, 542
    .long 544, 546, 548, 550, 552, 554, 556, 558
    .long 560, 562, 564, 566, 568, 570, 572, 574
    .long 576, 578, 580, 582, 584, 586, 588, 590
    .long 592, 594, 596, 598, 600, 602, 604, 606
    .long 608, 610, 612, 614, 616, 618, 620, 622
    .long 624, 626, 628, 630, 632, 634, 636, 638
    .long 640, 642, 644, 646, 648, 650, 652, 654
    .long 656, 658, 660, 662, 664, 666, 668, 670
    .long 672, 674, 676, 678, 680, 682, 684, 686
    .long 688, 690, 692, 694, 696, 698, 700, 702
    .long 704, 706, 708, 710, 712, 714, 716, 718
    .long 720, 722, 724, 726, 728, 730, 732, 734
    .long 736, 738, 740, 742, 744, 746, 748, 750
    .long 752, 754, 756, 758, 760, 762, 764, 766
    .long 768, 770, 896, 898, 772, 774, 900, 902
    .long 776, 778, 904, 906, 780, 782, 908, 910
    .long 784, 786, 912, 914, 788, 790, 916, 918
    .long 792, 794, 920, 922, 796, 798, 924, 926
    .long 800, 802, 928, 930, 804, 806, 932, 934
    .long 808, 810, 936, 938, 812, 814, 940, 942
    .long 816, 818, 944, 946, 820, 822, 948, 950
    .long 824, 826, 952, 954, 828, 830, 956, 958
    .long 832, 834, 960, 962, 836, 838, 964, 966
    .long 840, 842, 968, 970, 844, 846, 972, 974
    .long 848, 850, 976, 978, 852, 854, 980, 982
    .long 856, 858, 984, 986, 860, 862, 988, 990
    .long 864, 866, 992, 994, 868, 870, 996, 998
    .long 872, 874, 1000, 1002, 876, 878, 1004, 1006
    .long 880, 882, 1008, 1010, 884, 886, 1012, 1014
    .long 888, 890, 1016, 1018, 892, 894, 1020, 1022
    .long 1024, 1088, 1152, 1216, 1026, 1090, 1154, 1218
    .long 1028, 1092, 1156, 1220, 1030, 1094, 1158, 1222
    .long 1032, 1096, 1160, 1224, 1034, 1098, 1162, 1226
    .long 1036, 1100, 1164, 1228, 1038, 1102, 1166, 1230
    .long 1040, 1104, 1168, 1232, 1042, 1106, 1170, 1234
    .long 1044, 1108, 1172, 1236, 1046, 1110, 1174, 1238
    .long 1048, 1112, 1176, 1240, 1050, 1114, 1178, 1242
    .long 1052, 1116, 1180, 1244, 1054, 1118, 1182, 1246
    .long 1056, 1120, 1184, 1248, 1058, 1122, 1186, 1250
    .long 1060, 1124, 1188, 1252, 1062, 1126, 1190, 1254
    .long 1064, 1128, 1192, 1256, 1066, 1130, 1194, 1258
    .long 1068, 1132, 1196, 1260, 1070, 1134, 1198, 1262
    .long 1072, 1136, 1200, 1264, 1074, 1138, 1202, 1266
    .long 1076, 1140, 1204, 1268, 1078, 1142, 1206, 1270
    .long 1080, 1144, 1208, 1272, 1082, 1146, 1210, 1274
    .long 1084, 1148, 1212, 1276, 1086, 1150, 1214, 1278
    .long 1280, 1344, 1344, 1344, 1282, 1346, 1346, 1346
    .long 1284, 1348, 1348, 1348, 1286, 1350, 1350, 1350
    .long 1288, 1352, 1352, 1352, 1290, 1354, 1354, 1354
    .long 1292, 1356, 1356, 1356, 1294, 1358, 1358, 1358
    .long 1296, 1360, 1360, 1360, 1298, 1362, 1362, 1362
    .long 1300, 1364, 1364, 1364, 1302, 1366, 1366, 1366
    .long 1304, 1368, 1368, 1368, 1306, 1370, 1370, 1370
    .long 1308, 1372, 1372, 1372, 1310, 1374, 1374, 1374
    .long 1312, 1344, 1344, 1344, 1314, 1346, 1346, 1346
    .long 1316, 1348, 1348, 1348, 1318, 1350, 1350, 1350
    .long 1320, 1352, 1352, 1352, 1322, 1354, 1354, 1354
    .long 1324, 1356, 1356, 1356, 1326, 1358, 1358, 1358
    .long 1328, 1360, 1360, 1360, 1330, 1362, 1362, 1362
    .long 1332, 1364, 1364, 1364, 1334, 1366, 1366, 1366
    .long 1336, 1368, 1368, 1368, 1338, 1370, 1370, 1370
    .long 1340, 1372, 1372, 1372, 1342, 1374, 1374, 1374
    .long 1344, 1344, 1344, 1344, 1346, 1346, 1346, 1346
    .long 1348, 1348, 1348, 1348, 1350, 1350, 1350, 1350
    .long 1352, 1352, 1352, 1352, 1354, 1354, 1354, 1354
    .long 1356, 1356, 1356, 1356, 1358, 1358, 1358, 1358
    .long 1360, 1360, 1360, 1360, 1362, 1362, 1362, 1362
    .long 1364, 1364, 1364, 1364, 1366, 1366, 1366, 1366
    .long 1368, 1368, 1368, 1368, 1370, 1370, 1370, 1370
    .long 1372, 1372, 1372, 1372, 1374, 1374, 1374, 1374
    .long 1344, 1344, 1344, 1344, 1346, 1346, 1346, 1346
    .long 1348, 1348, 1348, 1348, 1350, 1350, 1350, 1350
    .long 1352, 1352, 1352, 1352, 1354, 1354, 1354, 1354
    .long 1356, 1356, 1356, 1356, 1358, 1358, 1358, 1358
    .long 1360, 1360, 1360, 1360, 1362, 1362, 1362, 1362
    .long 1364, 1364, 1364, 1364, 1366, 1366, 1366, 1366
    .long 1368, 1368, 1368, 1368, 1370, 1370, 1370, 1370
    .long 1372, 1372, 1372, 1372, 1374, 1374, 1374, 1374
    .long 1344, 1344, 1344, 1344, 1346, 1346, 1346, 1346
    .long 1348, 1348, 1348, 1348, 1350, 1350, 1350, 1350
    .long 1352, 1352, 1352, 1352, 1354, 1354, 1354, 1354
    .long 1356, 1356, 1356, 1356, 1358, 1358, 1358, 1358
    .long 1360, 1360, 1360, 1360, 1362, 1362, 1362, 1362
    .long 1364, 1364, 1364, 1364, 1366, 1366, 1366, 1366
    .long 1368, 1368, 1368, 1368, 1370, 1370, 1370, 1370
    .long 1372, 1372, 1372, 1372, 1374, 1374, 1374, 1374
    .long 1344, 1344, 1344, 1344, 1346, 1346, 1346, 1346
    .long 1348, 1348, 1348, 1348, 1350, 1350, 1350, 1350
    .long 1352, 1352, 1352, 1352, 1354, 1354, 1354, 1354
    .long 1356, 1356, 1356, 1356, 1358, 1358, 1358, 1358
    .long 1360, 1360, 1360, 1360, 1362, 1362, 1362, 1362
    .long 1364, 1364, 1364, 1364, 1366, 1366, 1366, 1366
    .long 1368, 1368, 1368, 1368, 1370, 1370, 1370, 1370
    .long 1372, 1372, 1372, 1372, 1374, 1374, 1374, 1374
    .long 1280, 1280, 1280, 1280, 1278, 1278, 1278, 1278
    .long 1278, 1278, 1278, 1276, 1276, 1276, 1276, 1276
    .long 1276, 1276, 1276, 1276, 1274, 1274, 1274, 1274
    .long 1274, 1274, 1274, 1272, 1272, 1272, 1272, 1272
    .long 1272, 1272, 1272, 1272, 1270, 1270, 1270, 1270
    .long 1270, 1270, 1270, 1268, 1268, 1268, 1268, 1268
    .long 1268, 1268, 1268, 1268, 1266, 1266, 1266, 1266
    .long 1266, 1266, 1266, 1264, 1264, 1264, 1264, 1264
    .long 1264, 1264, 1264, 1264, 1262, 1262, 1262, 1262
    .long 1262, 1262, 1262, 1260, 1260, 1260, 1260, 1260
    .long 1260, 1260, 1260, 1260, 1258, 1258, 1258, 1258
    .long 1258, 1258, 1258, 1256, 1256, 1256, 1256, 1256
    .long 1256, 1256, 1256, 1256, 1254, 1254, 1254, 1254
    .long 1254, 1254, 1254, 1252, 1252, 1252, 1252, 1252
    .long 1252, 1252, 1252, 1252, 1250, 1250, 1250, 1250
    .long 1250, 1250, 1250, 1248, 1248, 1248, 1248, 1248
    .long 1248, 1248, 1248, 1248, 1246, 1246, 1246, 1246
    .long 1246, 1246, 1246, 1244, 1244, 1244, 1244, 1244
    .long 1244, 1244, 1244, 1244, 1242, 1242, 1242, 1242
    .long 1242, 1242, 1242, 1240, 1240, 1240, 1240, 1240
    .long 1240, 1240, 1240, 1240, 1238, 1238, 1238, 1238
    .long 1238, 1238, 1238, 1236, 1236, 1236, 1236, 1236
    .long 1236, 1236, 1236, 1236, 1234, 1234, 1234, 1234
    .long 1234, 1234, 1234, 1232, 1232, 1232, 1232, 1232
    .long 1232, 1232, 1232, 1232, 1230, 1230, 1230, 1230
    .long 1230, 1230, 1230, 1228, 1228, 1228, 1228, 1228
    .long 1228, 1228, 1228, 1228, 1226, 1226, 1226, 1226
    .long 1226, 1226, 1226, 1224, 1224, 1224, 1224, 1224
    .long 1224, 1224, 1224, 1224, 1222, 1222, 1222, 1222
    .long 1222, 1222, 1222, 1220, 1220, 1220, 1220, 1220
    .long 1220, 1220, 1220, 1220, 1218, 1218, 1218, 1218
    .long 1218, 1218, 1218, 1216, 1216, 1216, 1216, 1216
    .long 1216, 1216, 1216, 1216, 1214, 1214, 1214, 1214
    .long 1214, 1214, 1214, 1212, 1212, 1212, 1212, 1212
    .long 1212, 1212, 1212, 1212, 1210, 1210, 1210, 1210
    .long 1210, 1210, 1210, 1208, 1208, 1208, 1208, 1208
    .long 1208, 1208, 1208, 1208, 1206, 1206, 1206, 1206
    .long 1206, 1206, 1206, 1204, 1204, 1204, 1204, 1204
    .long 1204, 1204, 1204, 1204, 1202, 1202, 1202, 1202
    .long 1202, 1202, 1202, 1200, 1200, 1200, 1200, 1200
    .long 1200, 1200, 1200, 1200, 1198, 1198, 1198, 1198
    .long 1198, 1198, 1198, 1196, 1196, 1196, 1196, 1196
    .long 1196, 1196, 1196, 1196, 1194, 1194, 1194, 1194
    .long 1194, 1194, 1194, 1192, 1192, 1192, 1192, 1192
    .long 1192, 1192, 1192, 1192, 1190, 1190, 1190, 1190
    .long 1190, 1190, 1190, 1188, 1188, 1188, 1188, 1188
    .long 1188, 1188, 1188, 1188, 1186, 1186, 1186, 1186
    .long 1186, 1186, 1186, 1184, 1184, 1184, 1184, 1184
    .long 1184, 1184, 1184, 1184, 1182, 1182, 1182, 1182
    .long 1182, 1182, 1182, 1180, 1180, 1180, 1180, 1180
    .long 1180, 1180, 1180, 1180, 1178, 1178, 1178, 1178
    .long 1178, 1178, 1178, 1176, 1176, 1176, 1176, 1176
    .long 1176, 1176, 1176, 1176, 1174, 1174, 1174, 1174
    .long 1174, 1174, 1174, 1172, 1172, 1172, 1172, 1172
    .long 1172, 1172, 1172, 1172, 1170, 1170, 1170, 1170
    .long 1170, 1170, 1170, 1168, 1168, 1168, 1168, 1168
    .long 1168, 1168, 1168, 1168, 1166, 1166, 1166, 1166
    .long 1166, 1166, 1166, 1164, 1164, 1164, 1164, 1164
    .long 1164, 1164, 1164, 1164, 1162, 1162, 1162, 1162
    .long 1162, 1162, 1162, 1160, 1160, 1160, 1160, 1160
    .long 1160, 1160, 1160, 1160, 1158, 1158, 1158, 1158
    .long 1158, 1158, 1158, 1156, 1156, 1156, 1156, 1156
    .long 1156, 1156, 1156, 1156, 1154, 1154, 1154, 1154
    .long 1154, 1154, 1154, 1152, 1152, 1152, 1152, 1152
    .long 1152, 1152, 1152, 1152, 1150, 1150, 1150, 1150
    .long 1150, 1150, 1150, 1148, 1148, 1148, 1148, 1148
    .long 1148, 1148, 1148, 1148, 1146, 1146, 1146, 1146
    .long 1146, 1146, 1146, 1144, 1144, 1144, 1144, 1144
    .long 1144, 1144, 1144, 1144, 1142, 1142, 1142, 1142
    .long 1142, 1142, 1142, 1140, 1140, 1140, 1140, 1140
    .long 1140, 1140, 1140, 1140, 1138, 1138, 1138, 1138
    .long 1138, 1138, 1138, 1136, 1136, 1136, 1136, 1136
    .long 1136, 1136, 1136, 1136, 1134, 1134, 1134, 1134
    .long 1134, 1134, 1134, 1132, 1132, 1132, 1132, 1132
    .long 1132, 1132, 1132, 1132, 1130, 1130, 1130, 1130
    .long 1130, 1130, 1130, 1128, 1128, 1128, 1128, 1128
    .long 1128, 1128, 1128, 1128, 1126, 1126, 1126, 1126
    .long 1126, 1126, 1126, 1124, 1124, 1124, 1124, 1124
    .long 1124, 1124, 1124, 1124, 1122, 1122, 1122, 1122
    .long 1122, 1122, 1122, 1120, 1120, 1120, 1120, 1120
    .long 1120, 1120, 1120, 1120, 1118, 1118, 1118, 1118
    .long 1118, 1118, 1118, 1116, 1116, 1116, 1116, 1116
    .long 1116, 1116, 1116, 1116, 1114, 1114, 1114, 1114
    .long 1114, 1114, 1114, 1112, 1112, 1112, 1112, 1112
    .long 1112, 1112, 1112, 1112, 1110, 1110, 1110, 1110
    .long 1110, 1110, 1110, 1108, 1108, 1108, 1108, 1108
    .long 1108, 1108, 1108, 1108, 1106, 1106, 1106, 1106
    .long 1106, 1106, 1106, 1104, 1104, 1104, 1104, 1104
    .long 1104, 1104, 1104, 1104, 1102, 1102, 1102, 1102
    .long 1102, 1102, 1102, 1100, 1100, 1100, 1100, 1100
    .long 1100, 1100, 1100, 1100, 1098, 1098, 1098, 1098
    .long 1098, 1098, 1098, 1096, 1096, 1096, 1096, 1096
    .long 1096, 1096, 1096, 1096, 1094, 1094, 1094, 1094
    .long 1094, 1094, 1094, 1092, 1092, 1092, 1092, 1092
    .long 1092, 1092, 1092, 1092, 1090, 1090, 1090, 1090
    .long 1090, 1090, 1090, 1088, 1088, 1088, 1088, 1088
    .long 1088, 1088, 1088, 1088, 1086, 1086, 1086, 1086
    .long 1086, 1086, 1086, 1084, 1084, 1084, 1084, 1084
    .long 1084, 1084, 1084, 1084, 1082, 1082, 1082, 1082
    .long 1082, 1082, 1082, 1080, 1080, 1080, 1080, 1080
    .long 1080, 1080, 1080, 1080, 1078, 1078, 1078, 1078
    .long 1078, 1078, 1078, 1076, 1076, 1076, 1076, 1076
    .long 1076, 1076, 1076, 1076, 1074, 1074, 1074, 1074
    .long 1074, 1074, 1074, 1072, 1072, 1072, 1072, 1072
    .long 1072, 1072, 1072, 1072, 1070, 1070, 1070, 1070
    .long 1070, 1070, 1070, 1068, 1068, 1068, 1068, 1068
    .long 1068, 1068, 1068, 1068, 1066, 1066, 1066, 1066
    .long 1066, 1066, 1066, 1064, 1064, 1064, 1064, 1064
    .long 1064, 1064, 1064, 1064, 1062, 1062, 1062, 1062
    .long 1062, 1062, 1062, 1060, 1060, 1060, 1060, 1060
    .long 1060, 1060, 1060, 1060, 1058, 1058, 1058, 1058
    .long 1058, 1058, 1058, 1056, 1056, 1056, 1056, 1056
    .long 1056, 1056, 1056, 1056, 1054, 1054, 1054, 1054
    .long 1054, 1054, 1054, 1052, 1052, 1052, 1052, 1052
    .long 1052, 1052, 1052, 1052, 1050, 1050, 1050, 1050
    .long 1050, 1050, 1050, 1048, 1048, 1048, 1048, 1048
    .long 1048, 1048, 1048, 1048, 1046, 1046, 1046, 1046
    .long 1046, 1046, 1046, 1044, 1044, 1044, 1044, 1044
    .long 1044, 1044, 1044, 1044, 1042, 1042, 1042, 1042
    .long 1042, 1042, 1042, 1040, 1040, 1040, 1040, 1040
    .long 1040, 1040, 1040, 1040, 1038, 1038, 1038, 1038
    .long 1038, 1038, 1038, 1036, 1036, 1036, 1036, 1036
    .long 1036, 1036, 1036, 1036, 1034, 1034, 1034, 1034
    .long 1034, 1034, 1034, 1032, 1032, 1032, 1032, 1032
    .long 1032, 1032, 1032, 1032, 1030, 1030, 1030, 1030
    .long 1030, 1030, 1030, 1028, 1028, 1028, 1028, 1028
    .long 1028, 1028, 1028, 1028, 1026, 1026, 1026, 1026
    .long 1026, 1026, 1026, 1024, 1024, 1024, 1024, 1024
    .long 1024, 1024, 1022, 1022, 1022, 1020, 1020, 1020
    .long 1020, 1020, 1018, 1018, 1018, 1016, 1016, 1016
    .long 1016, 1016, 1014, 1014, 1014, 1012, 1012, 1012
    .long 1012, 1012, 1010, 1010, 1010, 1008, 1008, 1008
    .long 1008, 1008, 1006, 1006, 1006, 1004, 1004, 1004
    .long 1004, 1004, 1002, 1002, 1002, 1000, 1000, 1000
    .long 1000, 1000, 998, 998, 998, 996, 996, 996
    .long 996, 996, 994, 994, 994, 992, 992, 992
    .long 992, 992, 990, 990, 990, 988, 988, 988
    .long 988, 988, 986, 986, 986, 984, 984, 984
    .long 984, 984, 982, 982, 982, 980, 980, 980
    .long 980, 980, 978, 978, 978, 976, 976, 976
    .long 976, 976, 974, 974, 974, 972, 972, 972
    .long 972, 972, 970, 970, 970, 968, 968, 968
    .long 968, 968, 966, 966, 966, 964, 964, 964
    .long 964, 964, 962, 962, 962, 960, 960, 960
    .long 960, 960, 958, 958, 958, 956, 956, 956
    .long 956, 956, 954, 954, 954, 952, 952, 952
    .long 952, 952, 950, 950, 950, 948, 948, 948
    .long 948, 948, 946, 946, 946, 944, 944, 944
    .long 944, 944, 942, 942, 942, 940, 940, 940
    .long 940, 940, 938, 938, 938, 936, 936, 936
    .long 936, 936, 934, 934, 934, 932, 932, 932
    .long 932, 932, 930, 930, 930, 928, 928, 928
    .long 928, 928, 926, 926, 926, 924, 924, 924
    .long 924, 924, 922, 922, 922, 920, 920, 920
    .long 920, 920, 918, 918, 918, 916, 916, 916
    .long 916, 916, 914, 914, 914, 912, 912, 912
    .long 912, 912, 910, 910, 910, 908, 908, 908
    .long 908, 908, 906, 906, 906, 904, 904, 904
    .long 904, 904, 902, 902, 902, 900, 900, 900
    .long 900, 900, 898, 898, 898, 896, 896, 896
    .long 896, 896, 894, 894, 894, 892, 892, 892
    .long 892, 892, 890, 890, 890, 888, 888, 888
    .long 888, 888, 886, 886, 886, 884, 884, 884
    .long 884, 884, 882, 882, 882, 880, 880, 880
    .long 880, 880, 878, 878, 878, 876, 876, 876
    .long 876, 876, 874, 874, 874, 872, 872, 872
    .long 872, 872, 870, 870, 870, 868, 868, 868
    .long 868, 868, 866, 866, 866, 864, 864, 864
    .long 864, 864, 862, 862, 862, 860, 860, 860
    .long 860, 860, 858, 858, 858, 856, 856, 856
    .long 856, 856, 854, 854, 854, 852, 852, 852
    .long 852, 852, 850, 850, 850, 848, 848, 848
    .long 848, 848, 846, 846, 846, 844, 844, 844
    .long 844, 844, 842, 842, 842, 840, 840, 840
    .long 840, 840, 838, 838, 838, 836, 836, 836
    .long 836, 836, 834, 834, 834, 832, 832, 832
    .long 832, 832, 830, 830, 830, 828, 828, 828
    .long 828, 828, 826, 826, 826, 824, 824, 824
    .long 824, 824, 822, 822, 822, 820, 820, 820
    .long 820, 820, 818, 818, 818, 816, 816, 816
    .long 816, 816, 814, 814, 814, 812, 812, 812
    .long 812, 812, 810, 810, 810, 808, 808, 808
    .long 808, 808, 806, 806, 806, 804, 804, 804
    .long 804, 804, 802, 802, 802, 800, 800, 800
    .long 800, 800, 798, 798, 798, 796, 796, 796
    .long 796, 796, 794, 794, 794, 792, 792, 792
    .long 792, 792, 790, 790, 790, 788, 788, 788
    .long 788, 788, 786, 786, 786, 784, 784, 784
    .long 784, 784, 782, 782, 782, 780, 780, 780
    .long 780, 780, 778, 778, 778, 776, 776, 776
    .long 776, 776, 774, 774, 774, 772, 772, 772
    .long 772, 772, 770, 770, 770, 768, 768, 768
    .long 768, 766, 764, 764, 764, 762, 760, 760
    .long 760, 758, 756, 756, 756, 754, 752, 752
    .long 752, 750, 748, 748, 748, 746, 744, 744
    .long 744, 742, 740, 740, 740, 738, 736, 736
    .long 736, 734, 732, 732, 732, 730, 728, 728
    .long 728, 726, 724, 724, 724, 722, 720, 720
    .long 720, 718, 716, 716, 716, 714, 712, 712
    .long 712, 710, 708, 708, 708, 706, 704, 704
    .long 704, 702, 700, 700, 700, 698, 696, 696
    .long 696, 694, 692, 692, 692, 690, 688, 688
    .long 688, 686, 684, 684, 684, 682, 680, 680
    .long 680, 678, 676, 676, 676, 674, 672, 672
    .long 672, 670, 668, 668, 668, 666, 664, 664
    .long 664, 662, 660, 660, 660, 658, 656, 656
    .long 656, 654, 652, 652, 652, 650, 648, 648
    .long 648, 646, 644, 644, 644, 642, 640, 640
    .long 640, 638, 636, 636, 636, 634, 632, 632
    .long 632, 630, 628, 628, 628, 626, 624, 624
    .long 624, 622, 620, 620, 620, 618, 616, 616
    .long 616, 614, 612, 612, 612, 610, 608, 608
    .long 608, 606, 604, 604, 604, 602, 600, 600
    .long 600, 598, 596, 596, 596, 594, 592, 592
    .long 592, 590, 588, 588, 588, 586, 584, 584
    .long 584, 582, 580, 580, 580, 578, 576, 576
    .long 576, 574, 572, 572, 572, 570, 568, 568
    .long 568, 566, 564, 564, 564, 562, 560, 560
    .long 560, 558, 556, 556, 556, 554, 552, 552
    .long 552, 550, 548, 548, 548, 546, 544, 544
    .long 544, 542, 540, 540, 540, 538, 536, 536
    .long 536, 534, 532, 532, 532, 530, 528, 528
    .long 528, 526, 524, 524, 524, 522, 520, 520
    .long 520, 518, 516, 516, 516, 514, 512, 512
    .long 510, 508, 506, 504, 502, 500, 498, 496
    .long 494, 492, 490, 488, 486, 484, 482, 480
    .long 478, 476, 474, 472, 470, 468, 466, 464
    .long 462, 460, 458, 456, 454, 452, 450, 448
    .long 446, 444, 442, 440, 438, 436, 434, 432
    .long 430, 428, 426, 424, 422, 420, 418, 416
    .long 414, 412, 410, 408, 406, 404, 402, 400
    .long 398, 396, 394, 392, 390, 388, 386, 384
    .long 382, 380, 378, 376, 374, 372, 370, 368
    .long 366, 364, 362, 360, 358, 356, 354, 352
    .long 350, 348, 346, 344, 342, 340, 338, 336
    .long 334, 332, 330, 328, 326, 324, 322, 320
    .long 318, 316, 314, 312, 310, 308, 306, 304
    .long 302, 300, 298, 296, 294, 292, 290, 288
    .long 286, 284, 282, 280, 278, 276, 274, 272
    .long 270, 268, 266, 264, 262, 260, 258, 256
    .long 254, 252, 250, 248, 246, 244, 242, 240
    .long 238, 236, 234, 232, 230, 228, 226, 224
    .long 222, 220, 218, 216, 214, 212, 210, 208
    .long 206, 204, 202, 200, 198, 196, 194, 192
    .long 190, 188, 186, 184, 182, 180, 178, 176
    .long 174, 172, 170, 168, 166, 164, 162, 160
    .long 158, 156, 154, 152, 150, 148, 146, 144
    .long 142, 140, 138, 136, 134, 132, 130, 128
    .long 126, 124, 122, 120, 118, 116, 114, 112
    .long 110, 108, 106, 104, 102, 100, 98, 96
    .long 94, 92, 90, 88, 86, 84, 82, 80
    .long 78, 76, 74, 72, 70, 68, 66, 64
    .long 62, 60, 58, 56, 54, 52, 50, 48
    .long 46, 44, 42, 40, 38, 36, 34, 32
    .long 30, 28, 26, 24, 22, 20, 18, 16
    .long 14, 12, 10, 8, 6, 4, 2, 0
    .long 1376, 1376, 1376, 1376, 1376, 1376, 1376, 1376
.size k12_tab1, 12320

    .globl k34_kernel
    .p2align 8
    .type k34_kernel,@function
k34_kernel:
    s_cmp_ge_u32 s2, 224
    s_cbranch_scc1 k34_end
    s_load_dwordx4 s[4:7], s[0:1], 80
    s_load_dwordx4 s[48:51], s[0:1], 96
    s_load_dwordx2 s[8:9], s[0:1], 120
    v_lshrrev_b32 v1, 6, v0
    v_and_b32 v2, 63, v0
    v_readfirstlane_b32 s47, v1
    s_and_b32 s10, s2, 7
    s_lshr_b32 s11, s2, 3
    s_lshr_b32 s12, s10, 1
    s_lshl_b32 s12, s12, 2
    s_and_b32 s13, s11, 3
    s_add_u32 s12, s12, s13
    s_and_b32 s13, s10, 1
    s_mul_i32 s13, s13, 7
    s_lshr_b32 s14, s11, 2
    s_add_u32 s13, s13, s14
    v_lshrrev_b32 v3, 4, v2
    v_and_b32 v4, 15, v2
    s_cmp_ge_u32 s47, 6
    s_cbranch_scc1 k34_stats
    s_cmp_ge_u32 s47, 4
    s_cbranch_scc1 k34_load
    s_mov_b32 s3, s47

    v_lshrrev_b32 v7, 2, v2
    v_and_b32 v24, 7, v7
    s_lshl_b32 s14, s3, 1
    v_xor_b32 v24, s14, v24
    v_and_b32 v25, 3, v2
    v_lshlrev_b32 v26, 8, v7
    v_lshl_add_u32 v26, v25, 3, v26

    v_xor_b32 v27, 0, v24
    v_lshl_add_u32 v8, v27, 5, v26
    v_xor_b32 v27, 1, v24
    v_lshl_add_u32 v9, v27, 5, v26
    v_xor_b32 v27, 2, v24
    v_lshl_add_u32 v10, v27, 5, v26
    v_xor_b32 v27, 3, v24
    v_lshl_add_u32 v11, v27, 5, v26
    v_xor_b32 v27, 4, v24
    v_lshl_add_u32 v12, v27, 5, v26
    v_xor_b32 v27, 5, v24
    v_lshl_add_u32 v13, v27, 5, v26
    v_xor_b32 v27, 6, v24
    v_lshl_add_u32 v14, v27, 5, v26
    v_xor_b32 v27, 7, v24
    v_lshl_add_u32 v15, v27, 5, v26
    v_add_u32 v16, 114688, v8
    v_add_u32 v17, 114688, v9
    v_mov_b32 v112, 0x3f803f80
    v_mov_b32 v113, 0x3f803f80
    v_mov_b32 v114, 0x3f803f80
    v_mov_b32 v115, 0x3f803f80
    s_waitcnt lgkmcnt(0)
    s_mov_b32 s52, s8
    s_mov_b32 s53, s9
    s_mov_b32 s54, 0x1800000
    s_mov_b32 s55, 0x20000
    s_lshl_b32 s14, s13, 9
    s_lshl_b32 s15, s3, 7
    s_add_u32 s14, s14, s15
    s_add_u32 s14, s14, 8388608
    s_add_u32 s15, s14, 7168
    v_lshlrev_b32 v27, 4, v3
    buffer_load_dwordx4 v[96:99], v27, s[52:55], s14 offen
    buffer_load_dwordx4 v[100:103], v27, s[52:55], s14 offen offset:64
    buffer_load_dwordx4 v[104:107], v27, s[52:55], s15 offen
    buffer_load_dwordx4 v[108:111], v27, s[52:55], s15 offen offset:64

    v_mov_b32 v128, 0
    v_mov_b32 v129, 0
    v_mov_b32 v130, 0
    v_mov_b32 v131, 0
    v_mov_b32 v132, 0
    v_mov_b32 v133, 0
    v_mov_b32 v134, 0
    v_mov_b32 v135, 0
    v_mov_b32 v136, 0
    v_mov_b32 v137, 0
    v_mov_b32 v138, 0
    v_mov_b32 v139, 0
    v_mov_b32 v140, 0
    v_mov_b32 v141, 0
    v_mov_b32 v142, 0
    v_mov_b32 v143, 0
    v_mov_b32 v144, 0
    v_mov_b32 v145, 0
    v_mov_b32 v146, 0
    v_mov_b32 v147, 0
    v_mov_b32 v148, 0
    v_mov_b32 v149, 0
    v_mov_b32 v150, 0
    v_mov_b32 v151, 0
    v_mov_b32 v152, 0
    v_mov_b32 v153, 0
    v_mov_b32 v154, 0
    v_mov_b32 v155, 0
    v_mov_b32 v156, 0
    v_mov_b32 v157, 0
    v_mov_b32 v158, 0
    v_mov_b32 v159, 0
    v_mov_b32 v160, 0
    v_mov_b32 v161, 0
    v_mov_b32 v162, 0
    v_mov_b32 v163, 0
    v_mov_b32 v164, 0
    v_mov_b32 v165, 0
    v_mov_b32 v166, 0
    v_mov_b32 v167, 0
    v_mov_b32 v168, 0
    v_mov_b32 v169, 0
    v_mov_b32 v170, 0
    v_mov_b32 v171, 0
    v_mov_b32 v172, 0
    v_mov_b32 v173, 0
    v_mov_b32 v174, 0
    v_mov_b32 v175, 0
    v_mov_b32 v176, 0
    v_mov_b32 v177, 0
    v_mov_b32 v178, 0
    v_mov_b32 v179, 0
    v_mov_b32 v180, 0
    v_mov_b32 v181, 0
    v_mov_b32 v182, 0
    v_mov_b32 v183, 0
    v_mov_b32 v184, 0
    v_mov_b32 v185, 0
    v_mov_b32 v186, 0
    v_mov_b32 v187, 0
    v_mov_b32 v188, 0
    v_mov_b32 v189, 0
    v_mov_b32 v190, 0
    v_mov_b32 v191, 0
    v_mov_b32 v192, 0
    v_mov_b32 v193, 0
    v_mov_b32 v194, 0
    v_mov_b32 v195, 0
    v_mov_b32 v196, 0
    v_mov_b32 v197, 0
    v_mov_b32 v198, 0
    v_mov_b32 v199, 0
    v_mov_b32 v200, 0
    v_mov_b32 v201, 0
    v_mov_b32 v202, 0
    v_mov_b32 v203, 0
    v_mov_b32 v204, 0
    v_mov_b32 v205, 0
    v_mov_b32 v206, 0
    v_mov_b32 v207, 0
    v_mov_b32 v208, 0
    v_mov_b32 v209, 0
    v_mov_b32 v210, 0
    v_mov_b32 v211, 0
    v_mov_b32 v212, 0
    v_mov_b32 v213, 0
    v_mov_b32 v214, 0
    v_mov_b32 v215, 0
    v_mov_b32 v216, 0
    v_mov_b32 v217, 0
    v_mov_b32 v218, 0
    v_mov_b32 v219, 0
    v_mov_b32 v220, 0
    v_mov_b32 v221, 0
    v_mov_b32 v222, 0
    v_mov_b32 v223, 0
    v_mov_b32 v224, 0
    v_mov_b32 v225, 0
    v_mov_b32 v226, 0
    v_mov_b32 v227, 0
    v_mov_b32 v228, 0
    v_mov_b32 v229, 0
    v_mov_b32 v230, 0
    v_mov_b32 v231, 0
    v_mov_b32 v232, 0
    v_mov_b32 v233, 0
    v_mov_b32 v234, 0
    v_mov_b32 v235, 0
    v_mov_b32 v236, 0
    v_mov_b32 v237, 0
    v_mov_b32 v238, 0
    v_mov_b32 v239, 0
    v_mov_b32 v240, 0
    v_mov_b32 v241, 0
    v_mov_b32 v242, 0
    v_mov_b32 v243, 0
    v_mov_b32 v244, 0
    v_mov_b32 v245, 0
    v_mov_b32 v246, 0
    v_mov_b32 v247, 0
    v_mov_b32 v248, 0
    v_mov_b32 v249, 0
    v_mov_b32 v250, 0
    v_mov_b32 v251, 0
    v_mov_b32 v252, 0
    v_mov_b32 v253, 0
    v_mov_b32 v254, 0
    v_mov_b32 v255, 0
    v_mov_b32 v116, 0
    v_mov_b32 v117, 0
    v_mov_b32 v118, 0
    v_mov_b32 v119, 0
    v_mov_b32 v120, 0
    v_mov_b32 v121, 0
    v_mov_b32 v122, 0
    v_mov_b32 v123, 0
    s_mov_b32 s45, 16384
    v_mov_b32 v18, v16
    v_mov_b32 v19, v17
    s_barrier

    ds_read_b64_tr_b16 v[64:65], v18 offset:0
    ds_read_b64_tr_b16 v[66:67], v18 offset:4096
    ds_read_b64_tr_b16 v[68:69], v19 offset:0
    ds_read_b64_tr_b16 v[70:71], v19 offset:4096
    ds_read_b64_tr_b16 v[72:73], v18 offset:8192
    ds_read_b64_tr_b16 v[74:75], v18 offset:12288
    ds_read_b64_tr_b16 v[76:77], v19 offset:8192
    ds_read_b64_tr_b16 v[78:79], v19 offset:12288
    ds_read_b64_tr_b16 v[32:33], v8 offset:0
    ds_read_b64_tr_b16 v[34:35], v8 offset:4096
    ds_read_b64_tr_b16 v[36:37], v9 offset:0
    ds_read_b64_tr_b16 v[38:39], v9 offset:4096
    ds_read_b64_tr_b16 v[40:41], v10 offset:0
    ds_read_b64_tr_b16 v[42:43], v10 offset:4096
    ds_read_b64_tr_b16 v[44:45], v11 offset:0
    ds_read_b64_tr_b16 v[46:47], v11 offset:4096
    ds_read_b64_tr_b16 v[48:49], v12 offset:0
    ds_read_b64_tr_b16 v[50:51], v12 offset:4096
    ds_read_b64_tr_b16 v[52:53], v13 offset:0
    ds_read_b64_tr_b16 v[54:55], v13 offset:4096
    ds_read_b64_tr_b16 v[56:57], v14 offset:0
    ds_read_b64_tr_b16 v[58:59], v14 offset:4096
    ds_read_b64_tr_b16 v[60:61], v15 offset:0
    ds_read_b64_tr_b16 v[62:63], v15 offset:4096
    v_add_u32 v18, s45, v16
    v_add_u32 v19, s45, v17
    s_mov_b32 s46, 0
k34_loop:
    s_waitcnt lgkmcnt(6)
    s_barrier
    v_mfma_f32_16x16x32_bf16 v[128:131], v[64:67], v[32:35], v[128:131]
    ds_read_b64_tr_b16 v[80:81], v18 offset:0
    v_mfma_f32_16x16x32_bf16 v[132:135], v[68:71], v[32:35], v[132:135]
    ds_read_b64_tr_b16 v[82:83], v18 offset:4096
    v_mfma_f32_16x16x32_bf16 v[136:139], v[72:75], v[32:35], v[136:139]
    v_mfma_f32_16x16x32_bf16 v[116:119], v[112:115], v[32:35], v[116:119]
    v_mfma_f32_16x16x32_bf16 v[140:143], v[76:79], v[32:35], v[140:143]
    ds_read_b64_tr_b16 v[32:33], v8 offset:8192
    v_mfma_f32_16x16x32_bf16 v[144:147], v[64:67], v[36:39], v[144:147]
    ds_read_b64_tr_b16 v[84:85], v19 offset:0
    v_mfma_f32_16x16x32_bf16 v[148:151], v[68:71], v[36:39], v[148:151]
    ds_read_b64_tr_b16 v[86:87], v19 offset:4096
    v_mfma_f32_16x16x32_bf16 v[152:155], v[72:75], v[36:39], v[152:155]
    v_mfma_f32_16x16x32_bf16 v[120:123], v[112:115], v[36:39], v[120:123]
    ds_read_b64_tr_b16 v[34:35], v8 offset:12288
    v_mfma_f32_16x16x32_bf16 v[156:159], v[76:79], v[36:39], v[156:159]
    ds_read_b64_tr_b16 v[36:37], v9 offset:8192
    s_waitcnt lgkmcnt(10)
    v_mfma_f32_16x16x32_bf16 v[160:163], v[64:67], v[40:43], v[160:163]
    ds_read_b64_tr_b16 v[88:89], v18 offset:8192
    v_mfma_f32_16x16x32_bf16 v[164:167], v[68:71], v[40:43], v[164:167]
    ds_read_b64_tr_b16 v[90:91], v18 offset:12288
    v_mfma_f32_16x16x32_bf16 v[168:171], v[72:75], v[40:43], v[168:171]
    ds_read_b64_tr_b16 v[38:39], v9 offset:12288
    v_mfma_f32_16x16x32_bf16 v[172:175], v[76:79], v[40:43], v[172:175]
    ds_read_b64_tr_b16 v[40:41], v10 offset:8192
    v_mfma_f32_16x16x32_bf16 v[176:179], v[64:67], v[44:47], v[176:179]
    ds_read_b64_tr_b16 v[92:93], v19 offset:8192
    v_mfma_f32_16x16x32_bf16 v[180:183], v[68:71], v[44:47], v[180:183]
    ds_read_b64_tr_b16 v[94:95], v19 offset:12288
    v_mfma_f32_16x16x32_bf16 v[184:187], v[72:75], v[44:47], v[184:187]
    ds_read_b64_tr_b16 v[42:43], v10 offset:12288
    v_mfma_f32_16x16x32_bf16 v[188:191], v[76:79], v[44:47], v[188:191]
    ds_read_b64_tr_b16 v[44:45], v11 offset:8192
    s_waitcnt lgkmcnt(10)
    v_mfma_f32_16x16x32_bf16 v[192:195], v[64:67], v[48:51], v[192:195]
    v_mfma_f32_16x16x32_bf16 v[196:199], v[68:71], v[48:51], v[196:199]
    v_mfma_f32_16x16x32_bf16 v[200:203], v[72:75], v[48:51], v[200:203]
    ds_read_b64_tr_b16 v[46:47], v11 offset:12288
    v_mfma_f32_16x16x32_bf16 v[204:207], v[76:79], v[48:51], v[204:207]
    ds_read_b64_tr_b16 v[48:49], v12 offset:8192
    v_mfma_f32_16x16x32_bf16 v[208:211], v[64:67], v[52:55], v[208:211]
    v_mfma_f32_16x16x32_bf16 v[212:215], v[68:71], v[52:55], v[212:215]
    s_add_u32 s45, s45, 16384
    v_mfma_f32_16x16x32_bf16 v[216:219], v[72:75], v[52:55], v[216:219]
    ds_read_b64_tr_b16 v[50:51], v12 offset:12288
    s_cmp_eq_u32 s45, 49152
    v_mfma_f32_16x16x32_bf16 v[220:223], v[76:79], v[52:55], v[220:223]
    ds_read_b64_tr_b16 v[52:53], v13 offset:8192
    s_waitcnt lgkmcnt(10)
    v_mfma_f32_16x16x32_bf16 v[224:227], v[64:67], v[56:59], v[224:227]
    v_mfma_f32_16x16x32_bf16 v[228:231], v[68:71], v[56:59], v[228:231]
    s_cselect_b32 s45, 0, s45
    v_mfma_f32_16x16x32_bf16 v[232:235], v[72:75], v[56:59], v[232:235]
    ds_read_b64_tr_b16 v[54:55], v13 offset:12288
    v_add_u32 v18, s45, v16
    v_mfma_f32_16x16x32_bf16 v[236:239], v[76:79], v[56:59], v[236:239]
    ds_read_b64_tr_b16 v[56:57], v14 offset:8192
    v_mfma_f32_16x16x32_bf16 v[240:243], v[64:67], v[60:63], v[240:243]
    v_mfma_f32_16x16x32_bf16 v[244:247], v[68:71], v[60:63], v[244:247]
    v_add_u32 v19, s45, v17
    v_mfma_f32_16x16x32_bf16 v[248:251], v[72:75], v[60:63], v[248:251]
    ds_read_b64_tr_b16 v[58:59], v14 offset:12288
    v_mfma_f32_16x16x32_bf16 v[252:255], v[76:79], v[60:63], v[252:255]
    ds_read_b64_tr_b16 v[60:61], v15 offset:8192
    ds_read_b64_tr_b16 v[62:63], v15 offset:12288
    s_waitcnt lgkmcnt(6)
    s_barrier
    v_mfma_f32_16x16x32_bf16 v[128:131], v[80:83], v[32:35], v[128:131]
    ds_read_b64_tr_b16 v[64:65], v18 offset:0
    v_mfma_f32_16x16x32_bf16 v[132:135], v[84:87], v[32:35], v[132:135]
    ds_read_b64_tr_b16 v[66:67], v18 offset:4096
    v_mfma_f32_16x16x32_bf16 v[136:139], v[88:91], v[32:35], v[136:139]
    v_mfma_f32_16x16x32_bf16 v[116:119], v[112:115], v[32:35], v[116:119]
    v_mfma_f32_16x16x32_bf16 v[140:143], v[92:95], v[32:35], v[140:143]
    ds_read_b64_tr_b16 v[32:33], v8 offset:16384
    v_mfma_f32_16x16x32_bf16 v[144:147], v[80:83], v[36:39], v[144:147]
    ds_read_b64_tr_b16 v[68:69], v19 offset:0
    v_mfma_f32_16x16x32_bf16 v[148:151], v[84:87], v[36:39], v[148:151]
    ds_read_b64_tr_b16 v[70:71], v19 offset:4096
    v_mfma_f32_16x16x32_bf16 v[152:155], v[88:91], v[36:39], v[152:155]
    v_mfma_f32_16x16x32_bf16 v[120:123], v[112:115], v[36:39], v[120:123]
    ds_read_b64_tr_b16 v[34:35], v8 offset:20480
    v_mfma_f32_16x16x32_bf16 v[156:159], v[92:95], v[36:39], v[156:159]
    ds_read_b64_tr_b16 v[36:37], v9 offset:16384
    v_add_u32 v8, 16384, v8
    s_waitcnt lgkmcnt(10)
    v_mfma_f32_16x16x32_bf16 v[160:163], v[80:83], v[40:43], v[160:163]
    ds_read_b64_tr_b16 v[72:73], v18 offset:8192
    v_mfma_f32_16x16x32_bf16 v[164:167], v[84:87], v[40:43], v[164:167]
    ds_read_b64_tr_b16 v[74:75], v18 offset:12288
    v_mfma_f32_16x16x32_bf16 v[168:171], v[88:91], v[40:43], v[168:171]
    ds_read_b64_tr_b16 v[38:39], v9 offset:20480
    v_mfma_f32_16x16x32_bf16 v[172:175], v[92:95], v[40:43], v[172:175]
    ds_read_b64_tr_b16 v[40:41], v10 offset:16384
    v_add_u32 v9, 16384, v9
    v_mfma_f32_16x16x32_bf16 v[176:179], v[80:83], v[44:47], v[176:179]
    ds_read_b64_tr_b16 v[76:77], v19 offset:8192
    v_mfma_f32_16x16x32_bf16 v[180:183], v[84:87], v[44:47], v[180:183]
    ds_read_b64_tr_b16 v[78:79], v19 offset:12288
    v_mfma_f32_16x16x32_bf16 v[184:187], v[88:91], v[44:47], v[184:187]
    ds_read_b64_tr_b16 v[42:43], v10 offset:20480
    v_mfma_f32_16x16x32_bf16 v[188:191], v[92:95], v[44:47], v[188:191]
    ds_read_b64_tr_b16 v[44:45], v11 offset:16384
    v_add_u32 v10, 16384, v10
    s_waitcnt lgkmcnt(10)
    v_mfma_f32_16x16x32_bf16 v[192:195], v[80:83], v[48:51], v[192:195]
    v_mfma_f32_16x16x32_bf16 v[196:199], v[84:87], v[48:51], v[196:199]
    v_mfma_f32_16x16x32_bf16 v[200:203], v[88:91], v[48:51], v[200:203]
    ds_read_b64_tr_b16 v[46:47], v11 offset:20480
    v_mfma_f32_16x16x32_bf16 v[204:207], v[92:95], v[48:51], v[204:207]
    ds_read_b64_tr_b16 v[48:49], v12 offset:16384
    v_add_u32 v11, 16384, v11
    v_mfma_f32_16x16x32_bf16 v[208:211], v[80:83], v[52:55], v[208:211]
    v_mfma_f32_16x16x32_bf16 v[212:215], v[84:87], v[52:55], v[212:215]
    s_add_u32 s45, s45, 16384
    v_mfma_f32_16x16x32_bf16 v[216:219], v[88:91], v[52:55], v[216:219]
    ds_read_b64_tr_b16 v[50:51], v12 offset:20480
    s_cmp_eq_u32 s45, 49152
    v_mfma_f32_16x16x32_bf16 v[220:223], v[92:95], v[52:55], v[220:223]
    ds_read_b64_tr_b16 v[52:53], v13 offset:16384
    v_add_u32 v12, 16384, v12
    s_waitcnt lgkmcnt(10)
    v_mfma_f32_16x16x32_bf16 v[224:227], v[80:83], v[56:59], v[224:227]
    v_mfma_f32_16x16x32_bf16 v[228:231], v[84:87], v[56:59], v[228:231]
    s_cselect_b32 s45, 0, s45
    v_mfma_f32_16x16x32_bf16 v[232:235], v[88:91], v[56:59], v[232:235]
    ds_read_b64_tr_b16 v[54:55], v13 offset:20480
    v_add_u32 v18, s45, v16
    v_mfma_f32_16x16x32_bf16 v[236:239], v[92:95], v[56:59], v[236:239]
    ds_read_b64_tr_b16 v[56:57], v14 offset:16384
    v_add_u32 v13, 16384, v13
    v_mfma_f32_16x16x32_bf16 v[240:243], v[80:83], v[60:63], v[240:243]
    s_add_u32 s46, s46, 2
    v_mfma_f32_16x16x32_bf16 v[244:247], v[84:87], v[60:63], v[244:247]
    v_add_u32 v19, s45, v17
    v_mfma_f32_16x16x32_bf16 v[248:251], v[88:91], v[60:63], v[248:251]
    s_cmp_lt_u32 s46, 14
    ds_read_b64_tr_b16 v[58:59], v14 offset:20480
    v_mfma_f32_16x16x32_bf16 v[252:255], v[92:95], v[60:63], v[252:255]
    ds_read_b64_tr_b16 v[60:61], v15 offset:16384
    ds_read_b64_tr_b16 v[62:63], v15 offset:20480
    v_add_u32 v14, 16384, v14
    v_add_u32 v15, 16384, v15
    s_cbranch_scc1 k34_loop

    s_waitcnt lgkmcnt(0)
    s_mov_b32 s15, 0xffff0000
    s_and_b32 s56, s13, 1
    s_lshr_b32 s57, s13, 1
    s_lshl_b32 s14, s56, 2
    s_add_u32 s58, s14, s3
    v_and_b32 v24, 7, v7
    v_xor_b32 v24, s58, v24
    v_lshl_add_u32 v24, v24, 5, v26
    s_lshl_b32 s14, s57, 14
    v_add_u32 v24, s14, v24
    ds_read_b64_tr_b16 v[8:9], v24
    ds_read_b64_tr_b16 v[10:11], v24 offset:4096
    ds_read_b64_tr_b16 v[12:13], v24 offset:8192
    ds_read_b64_tr_b16 v[14:15], v24 offset:12288
    v_mul_f32 v116, 0x3b124925, v116
    v_mul_f32 v120, 0x3b124925, v120
    v_cvt_pk_bf16_f32 v116, v116, v120
    v_and_b32 v120, s15, v116
    v_lshlrev_b32 v116, 16, v116
    v_lshlrev_b32 v28, 2, v4
    s_lshl_b32 s14, s3, 7
    s_add_u32 s14, s14, 114688
    v_add_u32 v29, s14, v28
    ds_write_b32 v29, v116
    ds_write_b32 v29, v120 offset:64
    s_mul_i32 s14, s12, 456
    s_lshl_b32 s17, s13, 2
    s_add_u32 s14, s14, s17
    s_add_u32 s14, s14, s3
    s_lshl_b32 s14, s14, 10
    s_add_u32 s14, s14, 16777216
    s_lshl_b32 s17, s3, 1
    v_lshlrev_b32 v30, 4, v2
    s_waitcnt lgkmcnt(0)
    s_barrier

    s_xor_b32 s18, s3, 0
    s_lshl_b32 s18, s18, 7
    s_add_u32 s18, s18, 114688
    v_add_u32 v31, s18, v28
    ds_read_b32 v32, v31
    ds_read_b32 v33, v31 offset:64
    s_xor_b32 s18, s3, 1
    s_lshl_b32 s18, s18, 7
    s_add_u32 s18, s18, 114688
    v_add_u32 v31, s18, v28
    ds_read_b32 v34, v31
    ds_read_b32 v35, v31 offset:64
    s_xor_b32 s18, s3, 2
    s_lshl_b32 s18, s18, 7
    s_add_u32 s18, s18, 114688
    v_add_u32 v31, s18, v28
    ds_read_b32 v36, v31
    ds_read_b32 v37, v31 offset:64
    s_xor_b32 s18, s3, 3
    s_lshl_b32 s18, s18, 7
    s_add_u32 s18, s18, 114688
    v_add_u32 v31, s18, v28
    ds_read_b32 v38, v31
    ds_read_b32 v39, v31 offset:64
    s_waitcnt vmcnt(0) lgkmcnt(0)
    v_pk_fma_f32 v[128:129], v[96:97], v[32:33], v[128:129] op_sel:[0,0,0] op_sel_hi:[1,0,1] neg_lo:[0,1,0] neg_hi:[0,1,0]
    v_pk_fma_f32 v[130:131], v[98:99], v[32:33], v[130:131] op_sel:[0,0,0] op_sel_hi:[1,0,1] neg_lo:[0,1,0] neg_hi:[0,1,0]
    v_pk_fma_f32 v[132:133], v[100:101], v[32:33], v[132:133] op_sel:[0,0,0] op_sel_hi:[1,0,1] neg_lo:[0,1,0] neg_hi:[0,1,0]
    v_pk_fma_f32 v[134:135], v[102:103], v[32:33], v[134:135] op_sel:[0,0,0] op_sel_hi:[1,0,1] neg_lo:[0,1,0] neg_hi:[0,1,0]
    v_pk_fma_f32 v[136:137], v[104:105], v[32:33], v[136:137] op_sel:[0,0,0] op_sel_hi:[1,0,1] neg_lo:[0,1,0] neg_hi:[0,1,0]
    v_pk_fma_f32 v[138:139], v[106:107], v[32:33], v[138:139] op_sel:[0,0,0] op_sel_hi:[1,0,1] neg_lo:[0,1,0] neg_hi:[0,1,0]
    v_pk_fma_f32 v[140:141], v[108:109], v[32:33], v[140:141] op_sel:[0,0,0] op_sel_hi:[1,0,1] neg_lo:[0,1,0] neg_hi:[0,1,0]
    v_pk_fma_f32 v[142:143], v[110:111], v[32:33], v[142:143] op_sel:[0,0,0] op_sel_hi:[1,0,1] neg_lo:[0,1,0] neg_hi:[0,1,0]
    v_pk_mul_f32 v[128:129], v[128:129], v[136:137]
    v_pk_mul_f32 v[130:131], v[130:131], v[138:139]
    v_pk_mul_f32 v[132:133], v[132:133], v[140:141]
    v_pk_mul_f32 v[134:135], v[134:135], v[142:143]
    v_cvt_pk_bf16_f32 v40, v128, v129
    v_cvt_pk_bf16_f32 v41, v130, v131
    v_cvt_pk_bf16_f32 v42, v132, v133
    v_cvt_pk_bf16_f32 v43, v134, v135
    s_xor_b32 s18, s17, 0
    s_mul_i32 s18, s18, 58368
    s_add_u32 s18, s18, s14
    buffer_store_dwordx4 v[40:43], v30, s[52:55], s18 offen sc1
    v_pk_fma_f32 v[144:145], v[96:97], v[32:33], v[144:145] op_sel:[0,1,0] op_sel_hi:[1,1,1] neg_lo:[0,1,0] neg_hi:[0,1,0]
    v_pk_fma_f32 v[146:147], v[98:99], v[32:33], v[146:147] op_sel:[0,1,0] op_sel_hi:[1,1,1] neg_lo:[0,1,0] neg_hi:[0,1,0]
    v_pk_fma_f32 v[148:149], v[100:101], v[32:33], v[148:149] op_sel:[0,1,0] op_sel_hi:[1,1,1] neg_lo:[0,1,0] neg_hi:[0,1,0]
    v_pk_fma_f32 v[150:151], v[102:103], v[32:33], v[150:151] op_sel:[0,1,0] op_sel_hi:[1,1,1] neg_lo:[0,1,0] neg_hi:[0,1,0]
    v_pk_fma_f32 v[152:153], v[104:105], v[32:33], v[152:153] op_sel:[0,1,0] op_sel_hi:[1,1,1] neg_lo:[0,1,0] neg_hi:[0,1,0]
    v_pk_fma_f32 v[154:155], v[106:107], v[32:33], v[154:155] op_sel:[0,1,0] op_sel_hi:[1,1,1] neg_lo:[0,1,0] neg_hi:[0,1,0]
    v_pk_fma_f32 v[156:157], v[108:109], v[32:33], v[156:157] op_sel:[0,1,0] op_sel_hi:[1,1,1] neg_lo:[0,1,0] neg_hi:[0,1,0]
    v_pk_fma_f32 v[158:159], v[110:111], v[32:33], v[158:159] op_sel:[0,1,0] op_sel_hi:[1,1,1] neg_lo:[0,1,0] neg_hi:[0,1,0]
    v_pk_mul_f32 v[144:145], v[144:145], v[152:153]
    v_pk_mul_f32 v[146:147], v[146:147], v[154:155]
    v_pk_mul_f32 v[148:149], v[148:149], v[156:157]
    v_pk_mul_f32 v[150:151], v[150:151], v[158:159]
    v_cvt_pk_bf16_f32 v44, v144, v145
    v_cvt_pk_bf16_f32 v45, v146, v147
    v_cvt_pk_bf16_f32 v46, v148, v149
    v_cvt_pk_bf16_f32 v47, v150, v151
    s_xor_b32 s18, s17, 1
    s_mul_i32 s18, s18, 58368
    s_add_u32 s18, s18, s14
    buffer_store_dwordx4 v[44:47], v30, s[52:55], s18 offen sc1
    v_pk_fma_f32 v[160:161], v[96:97], v[34:35], v[160:161] op_sel:[0,0,0] op_sel_hi:[1,0,1] neg_lo:[0,1,0] neg_hi:[0,1,0]
    v_pk_fma_f32 v[162:163], v[98:99], v[34:35], v[162:163] op_sel:[0,0,0] op_sel_hi:[1,0,1] neg_lo:[0,1,0] neg_hi:[0,1,0]
    v_pk_fma_f32 v[164:165], v[100:101], v[34:35], v[164:165] op_sel:[0,0,0] op_sel_hi:[1,0,1] neg_lo:[0,1,0] neg_hi:[0,1,0]
    v_pk_fma_f32 v[166:167], v[102:103], v[34:35], v[166:167] op_sel:[0,0,0] op_sel_hi:[1,0,1] neg_lo:[0,1,0] neg_hi:[0,1,0]
    v_pk_fma_f32 v[168:169], v[104:105], v[34:35], v[168:169] op_sel:[0,0,0] op_sel_hi:[1,0,1] neg_lo:[0,1,0] neg_hi:[0,1,0]
    v_pk_fma_f32 v[170:171], v[106:107], v[34:35], v[170:171] op_sel:[0,0,0] op_sel_hi:[1,0,1] neg_lo:[0,1,0] neg_hi:[0,1,0]
    v_pk_fma_f32 v[172:173], v[108:109], v[34:35], v[172:173] op_sel:[0,0,0] op_sel_hi:[1,0,1] neg_lo:[0,1,0] neg_hi:[0,1,0]
    v_pk_fma_f32 v[174:175], v[110:111], v[34:35], v[174:175] op_sel:[0,0,0] op_sel_hi:[1,0,1] neg_lo:[0,1,0] neg_hi:[0,1,0]
    v_pk_mul_f32 v[160:161], v[160:161], v[168:169]
    v_pk_mul_f32 v[162:163], v[162:163], v[170:171]
    v_pk_mul_f32 v[164:165], v[164:165], v[172:173]
    v_pk_mul_f32 v[166:167], v[166:167], v[174:175]
    v_cvt_pk_bf16_f32 v40, v160, v161
    v_cvt_pk_bf16_f32 v41, v162, v163
    v_cvt_pk_bf16_f32 v42, v164, v165
    v_cvt_pk_bf16_f32 v43, v166, v167
    s_xor_b32 s18, s17, 2
    s_mul_i32 s18, s18, 58368
    s_add_u32 s18, s18, s14
    buffer_store_dwordx4 v[40:43], v30, s[52:55], s18 offen sc1
    v_pk_fma_f32 v[176:177], v[96:97], v[34:35], v[176:177] op_sel:[0,1,0] op_sel_hi:[1,1,1] neg_lo:[0,1,0] neg_hi:[0,1,0]
    v_pk_fma_f32 v[178:179], v[98:99], v[34:35], v[178:179] op_sel:[0,1,0] op_sel_hi:[1,1,1] neg_lo:[0,1,0] neg_hi:[0,1,0]
    v_pk_fma_f32 v[180:181], v[100:101], v[34:35], v[180:181] op_sel:[0,1,0] op_sel_hi:[1,1,1] neg_lo:[0,1,0] neg_hi:[0,1,0]
    v_pk_fma_f32 v[182:183], v[102:103], v[34:35], v[182:183] op_sel:[0,1,0] op_sel_hi:[1,1,1] neg_lo:[0,1,0] neg_hi:[0,1,0]
    v_pk_fma_f32 v[184:185], v[104:105], v[34:35], v[184:185] op_sel:[0,1,0] op_sel_hi:[1,1,1] neg_lo:[0,1,0] neg_hi:[0,1,0]
    v_pk_fma_f32 v[186:187], v[106:107], v[34:35], v[186:187] op_sel:[0,1,0] op_sel_hi:[1,1,1] neg_lo:[0,1,0] neg_hi:[0,1,0]
    v_pk_fma_f32 v[188:189], v[108:109], v[34:35], v[188:189] op_sel:[0,1,0] op_sel_hi:[1,1,1] neg_lo:[0,1,0] neg_hi:[0,1,0]
    v_pk_fma_f32 v[190:191], v[110:111], v[34:35], v[190:191] op_sel:[0,1,0] op_sel_hi:[1,1,1] neg_lo:[0,1,0] neg_hi:[0,1,0]
    v_pk_mul_f32 v[176:177], v[176:177], v[184:185]
    v_pk_mul_f32 v[178:179], v[178:179], v[186:187]
    v_pk_mul_f32 v[180:181], v[180:181], v[188:189]
    v_pk_mul_f32 v[182:183], v[182:183], v[190:191]
    v_cvt_pk_bf16_f32 v44, v176, v177
    v_cvt_pk_bf16_f32 v45, v178, v179
    v_cvt_pk_bf16_f32 v46, v180, v181
    v_cvt_pk_bf16_f32 v47, v182, v183
    s_xor_b32 s18, s17, 3
    s_mul_i32 s18, s18, 58368
    s_add_u32 s18, s18, s14
    buffer_store_dwordx4 v[44:47], v30, s[52:55], s18 offen sc1
    v_pk_fma_f32 v[192:193], v[96:97], v[36:37], v[192:193] op_sel:[0,0,0] op_sel_hi:[1,0,1] neg_lo:[0,1,0] neg_hi:[0,1,0]
    v_pk_fma_f32 v[194:195], v[98:99], v[36:37], v[194:195] op_sel:[0,0,0] op_sel_hi:[1,0,1] neg_lo:[0,1,0] neg_hi:[0,1,0]
    v_pk_fma_f32 v[196:197], v[100:101], v[36:37], v[196:197] op_sel:[0,0,0] op_sel_hi:[1,0,1] neg_lo:[0,1,0] neg_hi:[0,1,0]
    v_pk_fma_f32 v[198:199], v[102:103], v[36:37], v[198:199] op_sel:[0,0,0] op_sel_hi:[1,0,1] neg_lo:[0,1,0] neg_hi:[0,1,0]
    v_pk_fma_f32 v[200:201], v[104:105], v[36:37], v[200:201] op_sel:[0,0,0] op_sel_hi:[1,0,1] neg_lo:[0,1,0] neg_hi:[0,1,0]
    v_pk_fma_f32 v[202:203], v[106:107], v[36:37], v[202:203] op_sel:[0,0,0] op_sel_hi:[1,0,1] neg_lo:[0,1,0] neg_hi:[0,1,0]
    v_pk_fma_f32 v[204:205], v[108:109], v[36:37], v[204:205] op_sel:[0,0,0] op_sel_hi:[1,0,1] neg_lo:[0,1,0] neg_hi:[0,1,0]
    v_pk_fma_f32 v[206:207], v[110:111], v[36:37], v[206:207] op_sel:[0,0,0] op_sel_hi:[1,0,1] neg_lo:[0,1,0] neg_hi:[0,1,0]
    v_pk_mul_f32 v[192:193], v[192:193], v[200:201]
    v_pk_mul_f32 v[194:195], v[194:195], v[202:203]
    v_pk_mul_f32 v[196:197], v[196:197], v[204:205]
    v_pk_mul_f32 v[198:199], v[198:199], v[206:207]
    v_cvt_pk_bf16_f32 v40, v192, v193
    v_cvt_pk_bf16_f32 v41, v194, v195
    v_cvt_pk_bf16_f32 v42, v196, v197
    v_cvt_pk_bf16_f32 v43, v198, v199
    s_xor_b32 s18, s17, 4
    s_mul_i32 s18, s18, 58368
    s_add_u32 s18, s18, s14
    buffer_store_dwordx4 v[40:43], v30, s[52:55], s18 offen sc1
    v_pk_fma_f32 v[208:209], v[96:97], v[36:37], v[208:209] op_sel:[0,1,0] op_sel_hi:[1,1,1] neg_lo:[0,1,0] neg_hi:[0,1,0]
    v_pk_fma_f32 v[210:211], v[98:99], v[36:37], v[210:211] op_sel:[0,1,0] op_sel_hi:[1,1,1] neg_lo:[0,1,0] neg_hi:[0,1,0]
    v_pk_fma_f32 v[212:213], v[100:101], v[36:37], v[212:213] op_sel:[0,1,0] op_sel_hi:[1,1,1] neg_lo:[0,1,0] neg_hi:[0,1,0]
    v_pk_fma_f32 v[214:215], v[102:103], v[36:37], v[214:215] op_sel:[0,1,0] op_sel_hi:[1,1,1] neg_lo:[0,1,0] neg_hi:[0,1,0]
    v_pk_fma_f32 v[216:217], v[104:105], v[36:37], v[216:217] op_sel:[0,1,0] op_sel_hi:[1,1,1] neg_lo:[0,1,0] neg_hi:[0,1,0]
    v_pk_fma_f32 v[218:219], v[106:107], v[36:37], v[218:219] op_sel:[0,1,0] op_sel_hi:[1,1,1] neg_lo:[0,1,0] neg_hi:[0,1,0]
    v_pk_fma_f32 v[220:221], v[108:109], v[36:37], v[220:221] op_sel:[0,1,0] op_sel_hi:[1,1,1] neg_lo:[0,1,0] neg_hi:[0,1,0]
    v_pk_fma_f32 v[222:223], v[110:111], v[36:37], v[222:223] op_sel:[0,1,0] op_sel_hi:[1,1,1] neg_lo:[0,1,0] neg_hi:[0,1,0]
    v_pk_mul_f32 v[208:209], v[208:209], v[216:217]
    v_pk_mul_f32 v[210:211], v[210:211], v[218:219]
    v_pk_mul_f32 v[212:213], v[212:213], v[220:221]
    v_pk_mul_f32 v[214:215], v[214:215], v[222:223]
    v_cvt_pk_bf16_f32 v44, v208, v209
    v_cvt_pk_bf16_f32 v45, v210, v211
    v_cvt_pk_bf16_f32 v46, v212, v213
    v_cvt_pk_bf16_f32 v47, v214, v215
    s_xor_b32 s18, s17, 5
    s_mul_i32 s18, s18, 58368
    s_add_u32 s18, s18, s14
    buffer_store_dwordx4 v[44:47], v30, s[52:55], s18 offen sc1
    v_pk_fma_f32 v[224:225], v[96:97], v[38:39], v[224:225] op_sel:[0,0,0] op_sel_hi:[1,0,1] neg_lo:[0,1,0] neg_hi:[0,1,0]
    v_pk_fma_f32 v[226:227], v[98:99], v[38:39], v[226:227] op_sel:[0,0,0] op_sel_hi:[1,0,1] neg_lo:[0,1,0] neg_hi:[0,1,0]
    v_pk_fma_f32 v[228:229], v[100:101], v[38:39], v[228:229] op_sel:[0,0,0] op_sel_hi:[1,0,1] neg_lo:[0,1,0] neg_hi:[0,1,0]
    v_pk_fma_f32 v[230:231], v[102:103], v[38:39], v[230:231] op_sel:[0,0,0] op_sel_hi:[1,0,1] neg_lo:[0,1,0] neg_hi:[0,1,0]
    v_pk_fma_f32 v[232:233], v[104:105], v[38:39], v[232:233] op_sel:[0,0,0] op_sel_hi:[1,0,1] neg_lo:[0,1,0] neg_hi:[0,1,0]
    v_pk_fma_f32 v[234:235], v[106:107], v[38:39], v[234:235] op_sel:[0,0,0] op_sel_hi:[1,0,1] neg_lo:[0,1,0] neg_hi:[0,1,0]
    v_pk_fma_f32 v[236:237], v[108:109], v[38:39], v[236:237] op_sel:[0,0,0] op_sel_hi:[1,0,1] neg_lo:[0,1,0] neg_hi:[0,1,0]
    v_pk_fma_f32 v[238:239], v[110:111], v[38:39], v[238:239] op_sel:[0,0,0] op_sel_hi:[1,0,1] neg_lo:[0,1,0] neg_hi:[0,1,0]
    v_pk_mul_f32 v[224:225], v[224:225], v[232:233]
    v_pk_mul_f32 v[226:227], v[226:227], v[234:235]
    v_pk_mul_f32 v[228:229], v[228:229], v[236:237]
    v_pk_mul_f32 v[230:231], v[230:231], v[238:239]
    v_cvt_pk_bf16_f32 v40, v224, v225
    v_cvt_pk_bf16_f32 v41, v226, v227
    v_cvt_pk_bf16_f32 v42, v228, v229
    v_cvt_pk_bf16_f32 v43, v230, v231
    s_xor_b32 s18, s17, 6
    s_mul_i32 s18, s18, 58368
    s_add_u32 s18, s18, s14
    buffer_store_dwordx4 v[40:43], v30, s[52:55], s18 offen sc1
    v_pk_fma_f32 v[240:241], v[96:97], v[38:39], v[240:241] op_sel:[0,1,0] op_sel_hi:[1,1,1] neg_lo:[0,1,0] neg_hi:[0,1,0]
    v_pk_fma_f32 v[242:243], v[98:99], v[38:39], v[242:243] op_sel:[0,1,0] op_sel_hi:[1,1,1] neg_lo:[0,1,0] neg_hi:[0,1,0]
    v_pk_fma_f32 v[244:245], v[100:101], v[38:39], v[244:245] op_sel:[0,1,0] op_sel_hi:[1,1,1] neg_lo:[0,1,0] neg_hi:[0,1,0]
    v_pk_fma_f32 v[246:247], v[102:103], v[38:39], v[246:247] op_sel:[0,1,0] op_sel_hi:[1,1,1] neg_lo:[0,1,0] neg_hi:[0,1,0]
    v_pk_fma_f32 v[248:249], v[104:105], v[38:39], v[248:249] op_sel:[0,1,0] op_sel_hi:[1,1,1] neg_lo:[0,1,0] neg_hi:[0,1,0]
    v_pk_fma_f32 v[250:251], v[106:107], v[38:39], v[250:251] op_sel:[0,1,0] op_sel_hi:[1,1,1] neg_lo:[0,1,0] neg_hi:[0,1,0]
    v_pk_fma_f32 v[252:253], v[108:109], v[38:39], v[252:253] op_sel:[0,1,0] op_sel_hi:[1,1,1] neg_lo:[0,1,0] neg_hi:[0,1,0]
    v_pk_fma_f32 v[254:255], v[110:111], v[38:39], v[254:255] op_sel:[0,1,0] op_sel_hi:[1,1,1] neg_lo:[0,1,0] neg_hi:[0,1,0]
    v_pk_mul_f32 v[240:241], v[240:241], v[248:249]
    v_pk_mul_f32 v[242:243], v[242:243], v[250:251]
    v_pk_mul_f32 v[244:245], v[244:245], v[252:253]
    v_pk_mul_f32 v[246:247], v[246:247], v[254:255]
    v_cvt_pk_bf16_f32 v44, v240, v241
    v_cvt_pk_bf16_f32 v45, v242, v243
    v_cvt_pk_bf16_f32 v46, v244, v245
    v_cvt_pk_bf16_f32 v47, v246, v247
    s_xor_b32 s18, s17, 7
    s_mul_i32 s18, s18, 58368
    s_add_u32 s18, s18, s14
    buffer_store_dwordx4 v[44:47], v30, s[52:55], s18 offen sc1
    s_barrier
    v_mov_b32 v128, 0
    v_mov_b32 v129, 0
    v_mov_b32 v130, 0
    v_mov_b32 v131, 0
    v_mov_b32 v132, 0
    v_mov_b32 v133, 0
    v_mov_b32 v134, 0
    v_mov_b32 v135, 0
    v_mov_b32 v136, 0
    v_mov_b32 v137, 0
    v_mov_b32 v138, 0
    v_mov_b32 v139, 0
    v_mov_b32 v140, 0
    v_mov_b32 v141, 0
    v_mov_b32 v142, 0
    v_mov_b32 v143, 0
    v_mov_b32 v144, 0
    v_mov_b32 v145, 0
    v_mov_b32 v146, 0
    v_mov_b32 v147, 0
    v_mov_b32 v148, 0
    v_mov_b32 v149, 0
    v_mov_b32 v150, 0
    v_mov_b32 v151, 0
    v_mov_b32 v152, 0
    v_mov_b32 v153, 0
    v_mov_b32 v154, 0
    v_mov_b32 v155, 0
    v_mov_b32 v156, 0
    v_mov_b32 v157, 0
    v_mov_b32 v158, 0
    v_mov_b32 v159, 0
    v_mov_b32 v160, 0
    v_mov_b32 v161, 0
    v_mov_b32 v162, 0
    v_mov_b32 v163, 0
    v_mov_b32 v164, 0
    v_mov_b32 v165, 0
    v_mov_b32 v166, 0
    v_mov_b32 v167, 0
    v_mov_b32 v168, 0
    v_mov_b32 v169, 0
    v_mov_b32 v170, 0
    v_mov_b32 v171, 0
    v_mov_b32 v172, 0
    v_mov_b32 v173, 0
    v_mov_b32 v174, 0
    v_mov_b32 v175, 0
    v_mov_b32 v176, 0
    v_mov_b32 v177, 0
    v_mov_b32 v178, 0
    v_mov_b32 v179, 0
    v_mov_b32 v180, 0
    v_mov_b32 v181, 0
    v_mov_b32 v182, 0
    v_mov_b32 v183, 0
    v_mov_b32 v184, 0
    v_mov_b32 v185, 0
    v_mov_b32 v186, 0
    v_mov_b32 v187, 0
    v_mov_b32 v188, 0
    v_mov_b32 v189, 0
    v_mov_b32 v190, 0
    v_mov_b32 v191, 0
    v_mov_b32 v1, v30
    s_xor_b32 s18, s3, 0
    s_mul_i32 s18, s18, 58368
    v_add_u32 v16, s18, v1
    s_xor_b32 s18, s3, 1
    s_mul_i32 s18, s18, 58368
    v_add_u32 v17, s18, v1
    s_xor_b32 s18, s3, 2
    s_mul_i32 s18, s18, 58368
    v_add_u32 v18, s18, v1
    s_xor_b32 s18, s3, 3
    s_mul_i32 s18, s18, 58368
    v_add_u32 v19, s18, v1
    v_lshrrev_b32 v5, 3, v2
    v_lshlrev_b32 v32, 7, v7
    v_lshl_add_u32 v32, v25, 3, v32
    s_lshl_b32 s59, s3, 12
    v_add_u32 v32, s59, v32
    v_bfe_u32 v33, v2, 3, 2

    v_xor_b32 v34, 0, v33
    v_lshl_add_u32 v20, v34, 5, v32
    v_add_u32 v24, 65536, v20
    v_add_u32 v28, 131072, v20
    v_xor_b32 v34, 1, v33
    v_lshl_add_u32 v21, v34, 5, v32
    v_add_u32 v25, 65536, v21
    v_add_u32 v29, 131072, v21
    v_xor_b32 v34, 2, v33
    v_lshl_add_u32 v22, v34, 5, v32
    v_add_u32 v26, 65536, v22
    v_add_u32 v30, 131072, v22
    v_xor_b32 v34, 3, v33
    v_lshl_add_u32 v23, v34, 5, v32
    v_add_u32 v27, 65536, v23
    v_add_u32 v31, 131072, v23
    s_lshl_b32 s40, s12, 3
    s_lshl_b32 s18, s56, 2
    s_add_u32 s40, s40, s18
    s_mul_i32 s40, s40, 57
    s_mul_i32 s18, s3, 14
    s_add_u32 s40, s40, s18
    s_lshl_b32 s40, s40, 10
    s_add_u32 s40, s40, 16777216
    s_lshl_b32 s18, s12, 7
    s_add_u32 s18, s18, 36864
    v_mov_b32 v34, s18
    v_mov_b32 v35, 1
    s_lshl_b32 s19, s12, 9
    s_lshl_b32 s18, s58, 6
    s_add_u32 s19, s19, s18
    s_add_u32 s19, s19, 8454144
    v_lshlrev_b32 v6, 2, v4
    s_waitcnt vmcnt(0)
    s_mov_b64 exec, 1
    buffer_atomic_add v35, v34, s[52:55], 0 offen sc1
    s_mov_b64 exec, -1
    s_barrier

    ds_read_b64_tr_b16 v[64:65], v20 offset:0
    ds_read_b64_tr_b16 v[66:67], v20 offset:2048
    ds_read_b64_tr_b16 v[68:69], v21 offset:0
    ds_read_b64_tr_b16 v[70:71], v21 offset:2048
    ds_read_b64_tr_b16 v[72:73], v22 offset:0
    ds_read_b64_tr_b16 v[74:75], v22 offset:2048
    ds_read_b64_tr_b16 v[76:77], v23 offset:0
    ds_read_b64_tr_b16 v[78:79], v23 offset:2048
    ds_read_b64_tr_b16 v[80:81], v20 offset:16384
    ds_read_b64_tr_b16 v[82:83], v20 offset:18432
    ds_read_b64_tr_b16 v[84:85], v21 offset:16384
    ds_read_b64_tr_b16 v[86:87], v21 offset:18432
    ds_read_b64_tr_b16 v[88:89], v22 offset:16384
    ds_read_b64_tr_b16 v[90:91], v22 offset:18432
    ds_read_b64_tr_b16 v[92:93], v23 offset:16384
    ds_read_b64_tr_b16 v[94:95], v23 offset:18432
    s_waitcnt lgkmcnt(0)
    ds_read_b64_tr_b16 v[96:97], v20 offset:32768
    ds_read_b64_tr_b16 v[98:99], v20 offset:34816
    ds_read_b64_tr_b16 v[100:101], v21 offset:32768
    ds_read_b64_tr_b16 v[102:103], v21 offset:34816
    ds_read_b64_tr_b16 v[104:105], v22 offset:32768
    ds_read_b64_tr_b16 v[106:107], v22 offset:34816
    ds_read_b64_tr_b16 v[108:109], v23 offset:32768
    ds_read_b64_tr_b16 v[110:111], v23 offset:34816
    ds_read_b64_tr_b16 v[112:113], v20 offset:49152
    ds_read_b64_tr_b16 v[114:115], v20 offset:51200
    ds_read_b64_tr_b16 v[116:117], v21 offset:49152
    ds_read_b64_tr_b16 v[118:119], v21 offset:51200
    ds_read_b64_tr_b16 v[120:121], v22 offset:49152
    ds_read_b64_tr_b16 v[122:123], v22 offset:51200
    ds_read_b64_tr_b16 v[124:125], v23 offset:49152
    ds_read_b64_tr_b16 v[126:127], v23 offset:51200
    s_waitcnt lgkmcnt(0)
    s_barrier
    s_barrier
    buffer_load_dword v6, v6, s[52:55], s19 offen sc1
    buffer_load_dwordx4 v[192:195], v16, s[52:55], s40 offen sc1
    buffer_load_dwordx4 v[196:199], v17, s[52:55], s40 offen sc1
    buffer_load_dwordx4 v[200:203], v18, s[52:55], s40 offen sc1
    buffer_load_dwordx4 v[204:207], v19, s[52:55], s40 offen sc1
    s_add_u32 s40, s40, 1024
    buffer_load_dwordx4 v[208:211], v16, s[52:55], s40 offen sc1
    buffer_load_dwordx4 v[212:215], v17, s[52:55], s40 offen sc1
    buffer_load_dwordx4 v[216:219], v18, s[52:55], s40 offen sc1
    buffer_load_dwordx4 v[220:223], v19, s[52:55], s40 offen sc1
    s_add_u32 s40, s40, 1024
    buffer_load_dwordx4 v[224:227], v16, s[52:55], s40 offen sc1
    buffer_load_dwordx4 v[228:231], v17, s[52:55], s40 offen sc1
    buffer_load_dwordx4 v[232:235], v18, s[52:55], s40 offen sc1
    buffer_load_dwordx4 v[236:239], v19, s[52:55], s40 offen sc1
    s_add_u32 s40, s40, 1024
    buffer_load_dwordx4 v[240:243], v16, s[52:55], s40 offen sc1
    buffer_load_dwordx4 v[244:247], v17, s[52:55], s40 offen sc1
    buffer_load_dwordx4 v[248:251], v18, s[52:55], s40 offen sc1
    buffer_load_dwordx4 v[252:255], v19, s[52:55], s40 offen sc1
    s_add_u32 s40, s40, 1024
    s_waitcnt vmcnt(12) lgkmcnt(0)
    v_mfma_f32_16x16x32_bf16 v[128:131], v[64:67], v[192:195], v[128:131]
    v_mfma_f32_16x16x32_bf16 v[144:147], v[64:67], v[196:199], v[144:147]
    v_mfma_f32_16x16x32_bf16 v[160:163], v[64:67], v[200:203], v[160:163]
    v_mfma_f32_16x16x32_bf16 v[176:179], v[64:67], v[204:207], v[176:179]
    v_mfma_f32_16x16x32_bf16 v[132:135], v[68:71], v[192:195], v[132:135]
    v_mfma_f32_16x16x32_bf16 v[148:151], v[68:71], v[196:199], v[148:151]
    v_mfma_f32_16x16x32_bf16 v[164:167], v[68:71], v[200:203], v[164:167]
    v_mfma_f32_16x16x32_bf16 v[180:183], v[68:71], v[204:207], v[180:183]
    v_mfma_f32_16x16x32_bf16 v[136:139], v[72:75], v[192:195], v[136:139]
    v_mfma_f32_16x16x32_bf16 v[152:155], v[72:75], v[196:199], v[152:155]
    v_mfma_f32_16x16x32_bf16 v[168:171], v[72:75], v[200:203], v[168:171]
    v_mfma_f32_16x16x32_bf16 v[184:187], v[72:75], v[204:207], v[184:187]
    v_mfma_f32_16x16x32_bf16 v[140:143], v[76:79], v[192:195], v[140:143]
    v_mfma_f32_16x16x32_bf16 v[156:159], v[76:79], v[196:199], v[156:159]
    v_mfma_f32_16x16x32_bf16 v[172:175], v[76:79], v[200:203], v[172:175]
    v_mfma_f32_16x16x32_bf16 v[188:191], v[76:79], v[204:207], v[188:191]
    buffer_load_dwordx4 v[192:195], v16, s[52:55], s40 offen sc1
    buffer_load_dwordx4 v[196:199], v17, s[52:55], s40 offen sc1
    buffer_load_dwordx4 v[200:203], v18, s[52:55], s40 offen sc1
    buffer_load_dwordx4 v[204:207], v19, s[52:55], s40 offen sc1
    s_add_u32 s40, s40, 1024
    s_waitcnt vmcnt(12) lgkmcnt(0)
    v_mfma_f32_16x16x32_bf16 v[128:131], v[80:83], v[208:211], v[128:131]
    v_mfma_f32_16x16x32_bf16 v[144:147], v[80:83], v[212:215], v[144:147]
    v_mfma_f32_16x16x32_bf16 v[160:163], v[80:83], v[216:219], v[160:163]
    v_mfma_f32_16x16x32_bf16 v[176:179], v[80:83], v[220:223], v[176:179]
    v_mfma_f32_16x16x32_bf16 v[132:135], v[84:87], v[208:211], v[132:135]
    v_mfma_f32_16x16x32_bf16 v[148:151], v[84:87], v[212:215], v[148:151]
    v_mfma_f32_16x16x32_bf16 v[164:167], v[84:87], v[216:219], v[164:167]
    v_mfma_f32_16x16x32_bf16 v[180:183], v[84:87], v[220:223], v[180:183]
    v_mfma_f32_16x16x32_bf16 v[136:139], v[88:91], v[208:211], v[136:139]
    v_mfma_f32_16x16x32_bf16 v[152:155], v[88:91], v[212:215], v[152:155]
    v_mfma_f32_16x16x32_bf16 v[168:171], v[88:91], v[216:219], v[168:171]
    v_mfma_f32_16x16x32_bf16 v[184:187], v[88:91], v[220:223], v[184:187]
    v_mfma_f32_16x16x32_bf16 v[140:143], v[92:95], v[208:211], v[140:143]
    v_mfma_f32_16x16x32_bf16 v[156:159], v[92:95], v[212:215], v[156:159]
    v_mfma_f32_16x16x32_bf16 v[172:175], v[92:95], v[216:219], v[172:175]
    v_mfma_f32_16x16x32_bf16 v[188:191], v[92:95], v[220:223], v[188:191]
    buffer_load_dwordx4 v[208:211], v16, s[52:55], s40 offen sc1
    buffer_load_dwordx4 v[212:215], v17, s[52:55], s40 offen sc1
    buffer_load_dwordx4 v[216:219], v18, s[52:55], s40 offen sc1
    buffer_load_dwordx4 v[220:223], v19, s[52:55], s40 offen sc1
    s_add_u32 s40, s40, 1024
    s_waitcnt vmcnt(12) lgkmcnt(0)
    v_mfma_f32_16x16x32_bf16 v[128:131], v[96:99], v[224:227], v[128:131]
    v_mfma_f32_16x16x32_bf16 v[144:147], v[96:99], v[228:231], v[144:147]
    v_mfma_f32_16x16x32_bf16 v[160:163], v[96:99], v[232:235], v[160:163]
    v_mfma_f32_16x16x32_bf16 v[176:179], v[96:99], v[236:239], v[176:179]
    v_mfma_f32_16x16x32_bf16 v[132:135], v[100:103], v[224:227], v[132:135]
    v_mfma_f32_16x16x32_bf16 v[148:151], v[100:103], v[228:231], v[148:151]
    v_mfma_f32_16x16x32_bf16 v[164:167], v[100:103], v[232:235], v[164:167]
    v_mfma_f32_16x16x32_bf16 v[180:183], v[100:103], v[236:239], v[180:183]
    v_mfma_f32_16x16x32_bf16 v[136:139], v[104:107], v[224:227], v[136:139]
    v_mfma_f32_16x16x32_bf16 v[152:155], v[104:107], v[228:231], v[152:155]
    v_mfma_f32_16x16x32_bf16 v[168:171], v[104:107], v[232:235], v[168:171]
    v_mfma_f32_16x16x32_bf16 v[184:187], v[104:107], v[236:239], v[184:187]
    v_mfma_f32_16x16x32_bf16 v[140:143], v[108:111], v[224:227], v[140:143]
    v_mfma_f32_16x16x32_bf16 v[156:159], v[108:111], v[228:231], v[156:159]
    v_mfma_f32_16x16x32_bf16 v[172:175], v[108:111], v[232:235], v[172:175]
    v_mfma_f32_16x16x32_bf16 v[188:191], v[108:111], v[236:239], v[188:191]
    buffer_load_dwordx4 v[224:227], v16, s[52:55], s40 offen sc1
    buffer_load_dwordx4 v[228:231], v17, s[52:55], s40 offen sc1
    buffer_load_dwordx4 v[232:235], v18, s[52:55], s40 offen sc1
    buffer_load_dwordx4 v[236:239], v19, s[52:55], s40 offen sc1
    s_add_u32 s40, s40, 1024
    s_waitcnt vmcnt(12) lgkmcnt(0)
    v_mfma_f32_16x16x32_bf16 v[128:131], v[112:115], v[240:243], v[128:131]
    ds_read_b64_tr_b16 v[32:33], v24 offset:0
    v_mfma_f32_16x16x32_bf16 v[144:147], v[112:115], v[244:247], v[144:147]
    v_mfma_f32_16x16x32_bf16 v[160:163], v[112:115], v[248:251], v[160:163]
    ds_read_b64_tr_b16 v[34:35], v24 offset:2048
    v_mfma_f32_16x16x32_bf16 v[176:179], v[112:115], v[252:255], v[176:179]
    v_mfma_f32_16x16x32_bf16 v[132:135], v[116:119], v[240:243], v[132:135]
    ds_read_b64_tr_b16 v[36:37], v25 offset:0
    v_mfma_f32_16x16x32_bf16 v[148:151], v[116:119], v[244:247], v[148:151]
    v_mfma_f32_16x16x32_bf16 v[164:167], v[116:119], v[248:251], v[164:167]
    ds_read_b64_tr_b16 v[38:39], v25 offset:2048
    v_mfma_f32_16x16x32_bf16 v[180:183], v[116:119], v[252:255], v[180:183]
    v_mfma_f32_16x16x32_bf16 v[136:139], v[120:123], v[240:243], v[136:139]
    ds_read_b64_tr_b16 v[40:41], v26 offset:0
    v_mfma_f32_16x16x32_bf16 v[152:155], v[120:123], v[244:247], v[152:155]
    v_mfma_f32_16x16x32_bf16 v[168:171], v[120:123], v[248:251], v[168:171]
    ds_read_b64_tr_b16 v[42:43], v26 offset:2048
    v_mfma_f32_16x16x32_bf16 v[184:187], v[120:123], v[252:255], v[184:187]
    v_mfma_f32_16x16x32_bf16 v[140:143], v[124:127], v[240:243], v[140:143]
    ds_read_b64_tr_b16 v[44:45], v27 offset:0
    v_mfma_f32_16x16x32_bf16 v[156:159], v[124:127], v[244:247], v[156:159]
    v_mfma_f32_16x16x32_bf16 v[172:175], v[124:127], v[248:251], v[172:175]
    ds_read_b64_tr_b16 v[46:47], v27 offset:2048
    v_mfma_f32_16x16x32_bf16 v[188:191], v[124:127], v[252:255], v[188:191]
    buffer_load_dwordx4 v[240:243], v16, s[52:55], s40 offen sc1
    buffer_load_dwordx4 v[244:247], v17, s[52:55], s40 offen sc1
    buffer_load_dwordx4 v[248:251], v18, s[52:55], s40 offen sc1
    buffer_load_dwordx4 v[252:255], v19, s[52:55], s40 offen sc1
    s_add_u32 s40, s40, 1024
    s_waitcnt vmcnt(12) lgkmcnt(0)
    v_mfma_f32_16x16x32_bf16 v[128:131], v[32:35], v[192:195], v[128:131]
    ds_read_b64_tr_b16 v[48:49], v24 offset:16384
    v_mfma_f32_16x16x32_bf16 v[144:147], v[32:35], v[196:199], v[144:147]
    v_mfma_f32_16x16x32_bf16 v[160:163], v[32:35], v[200:203], v[160:163]
    ds_read_b64_tr_b16 v[50:51], v24 offset:18432
    v_mfma_f32_16x16x32_bf16 v[176:179], v[32:35], v[204:207], v[176:179]
    v_mfma_f32_16x16x32_bf16 v[132:135], v[36:39], v[192:195], v[132:135]
    ds_read_b64_tr_b16 v[52:53], v25 offset:16384
    v_mfma_f32_16x16x32_bf16 v[148:151], v[36:39], v[196:199], v[148:151]
    v_mfma_f32_16x16x32_bf16 v[164:167], v[36:39], v[200:203], v[164:167]
    ds_read_b64_tr_b16 v[54:55], v25 offset:18432
    v_mfma_f32_16x16x32_bf16 v[180:183], v[36:39], v[204:207], v[180:183]
    v_mfma_f32_16x16x32_bf16 v[136:139], v[40:43], v[192:195], v[136:139]
    ds_read_b64_tr_b16 v[56:57], v26 offset:16384
    v_mfma_f32_16x16x32_bf16 v[152:155], v[40:43], v[196:199], v[152:155]
    v_mfma_f32_16x16x32_bf16 v[168:171], v[40:43], v[200:203], v[168:171]
    ds_read_b64_tr_b16 v[58:59], v26 offset:18432
    v_mfma_f32_16x16x32_bf16 v[184:187], v[40:43], v[204:207], v[184:187]
    v_mfma_f32_16x16x32_bf16 v[140:143], v[44:47], v[192:195], v[140:143]
    ds_read_b64_tr_b16 v[60:61], v27 offset:16384
    v_mfma_f32_16x16x32_bf16 v[156:159], v[44:47], v[196:199], v[156:159]
    v_mfma_f32_16x16x32_bf16 v[172:175], v[44:47], v[200:203], v[172:175]
    ds_read_b64_tr_b16 v[62:63], v27 offset:18432
    v_mfma_f32_16x16x32_bf16 v[188:191], v[44:47], v[204:207], v[188:191]
    buffer_load_dwordx4 v[192:195], v16, s[52:55], s40 offen sc1
    buffer_load_dwordx4 v[196:199], v17, s[52:55], s40 offen sc1
    buffer_load_dwordx4 v[200:203], v18, s[52:55], s40 offen sc1
    buffer_load_dwordx4 v[204:207], v19, s[52:55], s40 offen sc1
    s_add_u32 s40, s40, 1024
    s_waitcnt vmcnt(12) lgkmcnt(0)
    v_mfma_f32_16x16x32_bf16 v[128:131], v[48:51], v[208:211], v[128:131]
    ds_read_b64_tr_b16 v[32:33], v24 offset:32768
    v_mfma_f32_16x16x32_bf16 v[144:147], v[48:51], v[212:215], v[144:147]
    v_mfma_f32_16x16x32_bf16 v[160:163], v[48:51], v[216:219], v[160:163]
    ds_read_b64_tr_b16 v[34:35], v24 offset:34816
    v_mfma_f32_16x16x32_bf16 v[176:179], v[48:51], v[220:223], v[176:179]
    v_mfma_f32_16x16x32_bf16 v[132:135], v[52:55], v[208:211], v[132:135]
    ds_read_b64_tr_b16 v[36:37], v25 offset:32768
    v_mfma_f32_16x16x32_bf16 v[148:151], v[52:55], v[212:215], v[148:151]
    v_mfma_f32_16x16x32_bf16 v[164:167], v[52:55], v[216:219], v[164:167]
    ds_read_b64_tr_b16 v[38:39], v25 offset:34816
    v_mfma_f32_16x16x32_bf16 v[180:183], v[52:55], v[220:223], v[180:183]
    v_mfma_f32_16x16x32_bf16 v[136:139], v[56:59], v[208:211], v[136:139]
    ds_read_b64_tr_b16 v[40:41], v26 offset:32768
    v_mfma_f32_16x16x32_bf16 v[152:155], v[56:59], v[212:215], v[152:155]
    v_mfma_f32_16x16x32_bf16 v[168:171], v[56:59], v[216:219], v[168:171]
    ds_read_b64_tr_b16 v[42:43], v26 offset:34816
    v_mfma_f32_16x16x32_bf16 v[184:187], v[56:59], v[220:223], v[184:187]
    v_mfma_f32_16x16x32_bf16 v[140:143], v[60:63], v[208:211], v[140:143]
    ds_read_b64_tr_b16 v[44:45], v27 offset:32768
    v_mfma_f32_16x16x32_bf16 v[156:159], v[60:63], v[212:215], v[156:159]
    v_mfma_f32_16x16x32_bf16 v[172:175], v[60:63], v[216:219], v[172:175]
    ds_read_b64_tr_b16 v[46:47], v27 offset:34816
    v_mfma_f32_16x16x32_bf16 v[188:191], v[60:63], v[220:223], v[188:191]
    buffer_load_dwordx4 v[208:211], v16, s[52:55], s40 offen sc1
    buffer_load_dwordx4 v[212:215], v17, s[52:55], s40 offen sc1
    buffer_load_dwordx4 v[216:219], v18, s[52:55], s40 offen sc1
    buffer_load_dwordx4 v[220:223], v19, s[52:55], s40 offen sc1
    s_add_u32 s40, s40, 1024
    s_waitcnt vmcnt(12) lgkmcnt(0)
    v_mfma_f32_16x16x32_bf16 v[128:131], v[32:35], v[224:227], v[128:131]
    ds_read_b64_tr_b16 v[48:49], v24 offset:49152
    v_mfma_f32_16x16x32_bf16 v[144:147], v[32:35], v[228:231], v[144:147]
    v_mfma_f32_16x16x32_bf16 v[160:163], v[32:35], v[232:235], v[160:163]
    ds_read_b64_tr_b16 v[50:51], v24 offset:51200
    v_mfma_f32_16x16x32_bf16 v[176:179], v[32:35], v[236:239], v[176:179]
    v_mfma_f32_16x16x32_bf16 v[132:135], v[36:39], v[224:227], v[132:135]
    ds_read_b64_tr_b16 v[52:53], v25 offset:49152
    v_mfma_f32_16x16x32_bf16 v[148:151], v[36:39], v[228:231], v[148:151]
    v_mfma_f32_16x16x32_bf16 v[164:167], v[36:39], v[232:235], v[164:167]
    ds_read_b64_tr_b16 v[54:55], v25 offset:51200
    v_mfma_f32_16x16x32_bf16 v[180:183], v[36:39], v[236:239], v[180:183]
    v_mfma_f32_16x16x32_bf16 v[136:139], v[40:43], v[224:227], v[136:139]
    ds_read_b64_tr_b16 v[56:57], v26 offset:49152
    v_mfma_f32_16x16x32_bf16 v[152:155], v[40:43], v[228:231], v[152:155]
    v_mfma_f32_16x16x32_bf16 v[168:171], v[40:43], v[232:235], v[168:171]
    ds_read_b64_tr_b16 v[58:59], v26 offset:51200
    v_mfma_f32_16x16x32_bf16 v[184:187], v[40:43], v[236:239], v[184:187]
    v_mfma_f32_16x16x32_bf16 v[140:143], v[44:47], v[224:227], v[140:143]
    ds_read_b64_tr_b16 v[60:61], v27 offset:49152
    v_mfma_f32_16x16x32_bf16 v[156:159], v[44:47], v[228:231], v[156:159]
    v_mfma_f32_16x16x32_bf16 v[172:175], v[44:47], v[232:235], v[172:175]
    ds_read_b64_tr_b16 v[62:63], v27 offset:51200
    v_mfma_f32_16x16x32_bf16 v[188:191], v[44:47], v[236:239], v[188:191]
    buffer_load_dwordx4 v[224:227], v16, s[52:55], s40 offen sc1
    buffer_load_dwordx4 v[228:231], v17, s[52:55], s40 offen sc1
    buffer_load_dwordx4 v[232:235], v18, s[52:55], s40 offen sc1
    buffer_load_dwordx4 v[236:239], v19, s[52:55], s40 offen sc1
    s_add_u32 s40, s40, 1024
    s_waitcnt vmcnt(12) lgkmcnt(0)
    v_mfma_f32_16x16x32_bf16 v[128:131], v[48:51], v[240:243], v[128:131]
    ds_read_b64_tr_b16 v[32:33], v28 offset:0
    v_mfma_f32_16x16x32_bf16 v[144:147], v[48:51], v[244:247], v[144:147]
    v_mfma_f32_16x16x32_bf16 v[160:163], v[48:51], v[248:251], v[160:163]
    ds_read_b64_tr_b16 v[34:35], v28 offset:2048
    v_mfma_f32_16x16x32_bf16 v[176:179], v[48:51], v[252:255], v[176:179]
    v_mfma_f32_16x16x32_bf16 v[132:135], v[52:55], v[240:243], v[132:135]
    ds_read_b64_tr_b16 v[36:37], v29 offset:0
    v_mfma_f32_16x16x32_bf16 v[148:151], v[52:55], v[244:247], v[148:151]
    v_mfma_f32_16x16x32_bf16 v[164:167], v[52:55], v[248:251], v[164:167]
    ds_read_b64_tr_b16 v[38:39], v29 offset:2048
    v_mfma_f32_16x16x32_bf16 v[180:183], v[52:55], v[252:255], v[180:183]
    v_mfma_f32_16x16x32_bf16 v[136:139], v[56:59], v[240:243], v[136:139]
    ds_read_b64_tr_b16 v[40:41], v30 offset:0
    v_mfma_f32_16x16x32_bf16 v[152:155], v[56:59], v[244:247], v[152:155]
    v_mfma_f32_16x16x32_bf16 v[168:171], v[56:59], v[248:251], v[168:171]
    ds_read_b64_tr_b16 v[42:43], v30 offset:2048
    v_mfma_f32_16x16x32_bf16 v[184:187], v[56:59], v[252:255], v[184:187]
    v_mfma_f32_16x16x32_bf16 v[140:143], v[60:63], v[240:243], v[140:143]
    ds_read_b64_tr_b16 v[44:45], v31 offset:0
    v_mfma_f32_16x16x32_bf16 v[156:159], v[60:63], v[244:247], v[156:159]
    v_mfma_f32_16x16x32_bf16 v[172:175], v[60:63], v[248:251], v[172:175]
    ds_read_b64_tr_b16 v[46:47], v31 offset:2048
    v_mfma_f32_16x16x32_bf16 v[188:191], v[60:63], v[252:255], v[188:191]
    buffer_load_dwordx4 v[240:243], v16, s[52:55], s40 offen sc1
    buffer_load_dwordx4 v[244:247], v17, s[52:55], s40 offen sc1
    buffer_load_dwordx4 v[248:251], v18, s[52:55], s40 offen sc1
    buffer_load_dwordx4 v[252:255], v19, s[52:55], s40 offen sc1
    s_add_u32 s40, s40, 1024
    s_waitcnt vmcnt(12) lgkmcnt(0)
    v_mfma_f32_16x16x32_bf16 v[128:131], v[32:35], v[192:195], v[128:131]
    ds_read_b64_tr_b16 v[48:49], v28 offset:16384
    v_mfma_f32_16x16x32_bf16 v[144:147], v[32:35], v[196:199], v[144:147]
    v_mfma_f32_16x16x32_bf16 v[160:163], v[32:35], v[200:203], v[160:163]
    ds_read_b64_tr_b16 v[50:51], v28 offset:18432
    v_mfma_f32_16x16x32_bf16 v[176:179], v[32:35], v[204:207], v[176:179]
    v_mfma_f32_16x16x32_bf16 v[132:135], v[36:39], v[192:195], v[132:135]
    ds_read_b64_tr_b16 v[52:53], v29 offset:16384
    v_mfma_f32_16x16x32_bf16 v[148:151], v[36:39], v[196:199], v[148:151]
    v_mfma_f32_16x16x32_bf16 v[164:167], v[36:39], v[200:203], v[164:167]
    ds_read_b64_tr_b16 v[54:55], v29 offset:18432
    v_mfma_f32_16x16x32_bf16 v[180:183], v[36:39], v[204:207], v[180:183]
    v_mfma_f32_16x16x32_bf16 v[136:139], v[40:43], v[192:195], v[136:139]
    ds_read_b64_tr_b16 v[56:57], v30 offset:16384
    v_mfma_f32_16x16x32_bf16 v[152:155], v[40:43], v[196:199], v[152:155]
    v_mfma_f32_16x16x32_bf16 v[168:171], v[40:43], v[200:203], v[168:171]
    ds_read_b64_tr_b16 v[58:59], v30 offset:18432
    v_mfma_f32_16x16x32_bf16 v[184:187], v[40:43], v[204:207], v[184:187]
    v_mfma_f32_16x16x32_bf16 v[140:143], v[44:47], v[192:195], v[140:143]
    ds_read_b64_tr_b16 v[60:61], v31 offset:16384
    v_mfma_f32_16x16x32_bf16 v[156:159], v[44:47], v[196:199], v[156:159]
    v_mfma_f32_16x16x32_bf16 v[172:175], v[44:47], v[200:203], v[172:175]
    ds_read_b64_tr_b16 v[62:63], v31 offset:18432
    v_mfma_f32_16x16x32_bf16 v[188:191], v[44:47], v[204:207], v[188:191]
    buffer_load_dwordx4 v[192:195], v16, s[52:55], s40 offen sc1
    buffer_load_dwordx4 v[196:199], v17, s[52:55], s40 offen sc1
    buffer_load_dwordx4 v[200:203], v18, s[52:55], s40 offen sc1
    buffer_load_dwordx4 v[204:207], v19, s[52:55], s40 offen sc1
    s_add_u32 s40, s40, 1024
    s_waitcnt vmcnt(12) lgkmcnt(0)
    s_barrier
    v_mfma_f32_16x16x32_bf16 v[128:131], v[48:51], v[208:211], v[128:131]
    ds_read_b64_tr_b16 v[32:33], v20 offset:0
    v_mfma_f32_16x16x32_bf16 v[144:147], v[48:51], v[212:215], v[144:147]
    v_mfma_f32_16x16x32_bf16 v[160:163], v[48:51], v[216:219], v[160:163]
    ds_read_b64_tr_b16 v[34:35], v20 offset:2048
    v_mfma_f32_16x16x32_bf16 v[176:179], v[48:51], v[220:223], v[176:179]
    v_mfma_f32_16x16x32_bf16 v[132:135], v[52:55], v[208:211], v[132:135]
    ds_read_b64_tr_b16 v[36:37], v21 offset:0
    v_mfma_f32_16x16x32_bf16 v[148:151], v[52:55], v[212:215], v[148:151]
    v_mfma_f32_16x16x32_bf16 v[164:167], v[52:55], v[216:219], v[164:167]
    ds_read_b64_tr_b16 v[38:39], v21 offset:2048
    v_mfma_f32_16x16x32_bf16 v[180:183], v[52:55], v[220:223], v[180:183]
    v_mfma_f32_16x16x32_bf16 v[136:139], v[56:59], v[208:211], v[136:139]
    ds_read_b64_tr_b16 v[40:41], v22 offset:0
    v_mfma_f32_16x16x32_bf16 v[152:155], v[56:59], v[212:215], v[152:155]
    v_mfma_f32_16x16x32_bf16 v[168:171], v[56:59], v[216:219], v[168:171]
    ds_read_b64_tr_b16 v[42:43], v22 offset:2048
    v_mfma_f32_16x16x32_bf16 v[184:187], v[56:59], v[220:223], v[184:187]
    v_mfma_f32_16x16x32_bf16 v[140:143], v[60:63], v[208:211], v[140:143]
    ds_read_b64_tr_b16 v[44:45], v23 offset:0
    v_mfma_f32_16x16x32_bf16 v[156:159], v[60:63], v[212:215], v[156:159]
    v_mfma_f32_16x16x32_bf16 v[172:175], v[60:63], v[216:219], v[172:175]
    ds_read_b64_tr_b16 v[46:47], v23 offset:2048
    v_mfma_f32_16x16x32_bf16 v[188:191], v[60:63], v[220:223], v[188:191]
    buffer_load_dwordx4 v[208:211], v16, s[52:55], s40 offen sc1
    buffer_load_dwordx4 v[212:215], v17, s[52:55], s40 offen sc1
    buffer_load_dwordx4 v[216:219], v18, s[52:55], s40 offen sc1
    buffer_load_dwordx4 v[220:223], v19, s[52:55], s40 offen sc1
    s_add_u32 s40, s40, 1024
    s_waitcnt vmcnt(12) lgkmcnt(0)
    v_mfma_f32_16x16x32_bf16 v[128:131], v[32:35], v[224:227], v[128:131]
    ds_read_b64_tr_b16 v[48:49], v20 offset:16384
    v_mfma_f32_16x16x32_bf16 v[144:147], v[32:35], v[228:231], v[144:147]
    v_mfma_f32_16x16x32_bf16 v[160:163], v[32:35], v[232:235], v[160:163]
    ds_read_b64_tr_b16 v[50:51], v20 offset:18432
    v_mfma_f32_16x16x32_bf16 v[176:179], v[32:35], v[236:239], v[176:179]
    v_mfma_f32_16x16x32_bf16 v[132:135], v[36:39], v[224:227], v[132:135]
    ds_read_b64_tr_b16 v[52:53], v21 offset:16384
    v_mfma_f32_16x16x32_bf16 v[148:151], v[36:39], v[228:231], v[148:151]
    v_mfma_f32_16x16x32_bf16 v[164:167], v[36:39], v[232:235], v[164:167]
    ds_read_b64_tr_b16 v[54:55], v21 offset:18432
    v_mfma_f32_16x16x32_bf16 v[180:183], v[36:39], v[236:239], v[180:183]
    v_mfma_f32_16x16x32_bf16 v[136:139], v[40:43], v[224:227], v[136:139]
    ds_read_b64_tr_b16 v[56:57], v22 offset:16384
    v_mfma_f32_16x16x32_bf16 v[152:155], v[40:43], v[228:231], v[152:155]
    v_mfma_f32_16x16x32_bf16 v[168:171], v[40:43], v[232:235], v[168:171]
    ds_read_b64_tr_b16 v[58:59], v22 offset:18432
    v_mfma_f32_16x16x32_bf16 v[184:187], v[40:43], v[236:239], v[184:187]
    v_mfma_f32_16x16x32_bf16 v[140:143], v[44:47], v[224:227], v[140:143]
    ds_read_b64_tr_b16 v[60:61], v23 offset:16384
    v_mfma_f32_16x16x32_bf16 v[156:159], v[44:47], v[228:231], v[156:159]
    v_mfma_f32_16x16x32_bf16 v[172:175], v[44:47], v[232:235], v[172:175]
    ds_read_b64_tr_b16 v[62:63], v23 offset:18432
    v_mfma_f32_16x16x32_bf16 v[188:191], v[44:47], v[236:239], v[188:191]
    s_waitcnt vmcnt(8) lgkmcnt(0)
    v_mfma_f32_16x16x32_bf16 v[128:131], v[48:51], v[240:243], v[128:131]
    ds_read_b64_tr_b16 v[32:33], v20 offset:32768
    v_mfma_f32_16x16x32_bf16 v[144:147], v[48:51], v[244:247], v[144:147]
    v_mfma_f32_16x16x32_bf16 v[160:163], v[48:51], v[248:251], v[160:163]
    ds_read_b64_tr_b16 v[34:35], v20 offset:34816
    v_mfma_f32_16x16x32_bf16 v[176:179], v[48:51], v[252:255], v[176:179]
    v_mfma_f32_16x16x32_bf16 v[132:135], v[52:55], v[240:243], v[132:135]
    ds_read_b64_tr_b16 v[36:37], v21 offset:32768
    v_mfma_f32_16x16x32_bf16 v[148:151], v[52:55], v[244:247], v[148:151]
    v_mfma_f32_16x16x32_bf16 v[164:167], v[52:55], v[248:251], v[164:167]
    ds_read_b64_tr_b16 v[38:39], v21 offset:34816
    v_mfma_f32_16x16x32_bf16 v[180:183], v[52:55], v[252:255], v[180:183]
    v_mfma_f32_16x16x32_bf16 v[136:139], v[56:59], v[240:243], v[136:139]
    ds_read_b64_tr_b16 v[40:41], v22 offset:32768
    v_mfma_f32_16x16x32_bf16 v[152:155], v[56:59], v[244:247], v[152:155]
    v_mfma_f32_16x16x32_bf16 v[168:171], v[56:59], v[248:251], v[168:171]
    ds_read_b64_tr_b16 v[42:43], v22 offset:34816
    v_mfma_f32_16x16x32_bf16 v[184:187], v[56:59], v[252:255], v[184:187]
    v_mfma_f32_16x16x32_bf16 v[140:143], v[60:63], v[240:243], v[140:143]
    ds_read_b64_tr_b16 v[44:45], v23 offset:32768
    v_mfma_f32_16x16x32_bf16 v[156:159], v[60:63], v[244:247], v[156:159]
    v_mfma_f32_16x16x32_bf16 v[172:175], v[60:63], v[248:251], v[172:175]
    ds_read_b64_tr_b16 v[46:47], v23 offset:34816
    v_mfma_f32_16x16x32_bf16 v[188:191], v[60:63], v[252:255], v[188:191]
    s_waitcnt vmcnt(4) lgkmcnt(0)
    v_mfma_f32_16x16x32_bf16 v[128:131], v[32:35], v[192:195], v[128:131]
    ds_read_b64_tr_b16 v[48:49], v20 offset:49152
    v_mfma_f32_16x16x32_bf16 v[144:147], v[32:35], v[196:199], v[144:147]
    v_mfma_f32_16x16x32_bf16 v[160:163], v[32:35], v[200:203], v[160:163]
    ds_read_b64_tr_b16 v[50:51], v20 offset:51200
    v_mfma_f32_16x16x32_bf16 v[176:179], v[32:35], v[204:207], v[176:179]
    v_mfma_f32_16x16x32_bf16 v[132:135], v[36:39], v[192:195], v[132:135]
    ds_read_b64_tr_b16 v[52:53], v21 offset:49152
    v_mfma_f32_16x16x32_bf16 v[148:151], v[36:39], v[196:199], v[148:151]
    v_mfma_f32_16x16x32_bf16 v[164:167], v[36:39], v[200:203], v[164:167]
    ds_read_b64_tr_b16 v[54:55], v21 offset:51200
    v_mfma_f32_16x16x32_bf16 v[180:183], v[36:39], v[204:207], v[180:183]
    v_mfma_f32_16x16x32_bf16 v[136:139], v[40:43], v[192:195], v[136:139]
    ds_read_b64_tr_b16 v[56:57], v22 offset:49152
    v_mfma_f32_16x16x32_bf16 v[152:155], v[40:43], v[196:199], v[152:155]
    v_mfma_f32_16x16x32_bf16 v[168:171], v[40:43], v[200:203], v[168:171]
    ds_read_b64_tr_b16 v[58:59], v22 offset:51200
    v_mfma_f32_16x16x32_bf16 v[184:187], v[40:43], v[204:207], v[184:187]
    v_mfma_f32_16x16x32_bf16 v[140:143], v[44:47], v[192:195], v[140:143]
    ds_read_b64_tr_b16 v[60:61], v23 offset:49152
    v_mfma_f32_16x16x32_bf16 v[156:159], v[44:47], v[196:199], v[156:159]
    v_mfma_f32_16x16x32_bf16 v[172:175], v[44:47], v[200:203], v[172:175]
    ds_read_b64_tr_b16 v[62:63], v23 offset:51200
    v_mfma_f32_16x16x32_bf16 v[188:191], v[44:47], v[204:207], v[188:191]
    s_waitcnt vmcnt(0) lgkmcnt(0)
    v_mfma_f32_16x16x32_bf16 v[128:131], v[48:51], v[208:211], v[128:131]
    v_mfma_f32_16x16x32_bf16 v[144:147], v[48:51], v[212:215], v[144:147]
    v_mfma_f32_16x16x32_bf16 v[160:163], v[48:51], v[216:219], v[160:163]
    v_mfma_f32_16x16x32_bf16 v[176:179], v[48:51], v[220:223], v[176:179]
    v_mfma_f32_16x16x32_bf16 v[132:135], v[52:55], v[208:211], v[132:135]
    v_mfma_f32_16x16x32_bf16 v[148:151], v[52:55], v[212:215], v[148:151]
    v_mfma_f32_16x16x32_bf16 v[164:167], v[52:55], v[216:219], v[164:167]
    v_mfma_f32_16x16x32_bf16 v[180:183], v[52:55], v[220:223], v[180:183]
    v_mfma_f32_16x16x32_bf16 v[136:139], v[56:59], v[208:211], v[136:139]
    v_mfma_f32_16x16x32_bf16 v[152:155], v[56:59], v[212:215], v[152:155]
    v_mfma_f32_16x16x32_bf16 v[168:171], v[56:59], v[216:219], v[168:171]
    v_mfma_f32_16x16x32_bf16 v[184:187], v[56:59], v[220:223], v[184:187]
    v_mfma_f32_16x16x32_bf16 v[140:143], v[60:63], v[208:211], v[140:143]
    v_mfma_f32_16x16x32_bf16 v[156:159], v[60:63], v[212:215], v[156:159]
    v_mfma_f32_16x16x32_bf16 v[172:175], v[60:63], v[216:219], v[172:175]
    v_mfma_f32_16x16x32_bf16 v[188:191], v[60:63], v[220:223], v[188:191]
    v_add_u32 v32, s59, v1
    s_nop 7

    ds_write_b128 v32, v[144:147] offset:0
    ds_write_b128 v32, v[148:151] offset:1024
    ds_write_b128 v32, v[152:155] offset:2048
    ds_write_b128 v32, v[156:159] offset:3072
    ds_write_b128 v32, v[160:163] offset:16384
    ds_write_b128 v32, v[164:167] offset:17408
    ds_write_b128 v32, v[168:171] offset:18432
    ds_write_b128 v32, v[172:175] offset:19456
    ds_write_b128 v32, v[176:179] offset:32768
    ds_write_b128 v32, v[180:183] offset:33792
    ds_write_b128 v32, v[184:187] offset:34816
    ds_write_b128 v32, v[188:191] offset:35840
    s_waitcnt lgkmcnt(0)
    s_barrier
    s_xor_b32 s18, s3, 1
    s_lshl_b32 s18, s18, 12
    v_add_u32 v33, s18, v1
    ds_read_b128 v[144:147], v33 offset:0
    ds_read_b128 v[148:151], v33 offset:1024
    ds_read_b128 v[152:155], v33 offset:2048
    ds_read_b128 v[156:159], v33 offset:3072
    s_xor_b32 s18, s3, 2
    s_lshl_b32 s18, s18, 12
    v_add_u32 v33, s18, v1
    ds_read_b128 v[160:163], v33 offset:16384
    ds_read_b128 v[164:167], v33 offset:17408
    ds_read_b128 v[168:171], v33 offset:18432
    ds_read_b128 v[172:175], v33 offset:19456
    s_xor_b32 s18, s3, 3
    s_lshl_b32 s18, s18, 12
    v_add_u32 v33, s18, v1
    ds_read_b128 v[176:179], v33 offset:32768
    ds_read_b128 v[180:183], v33 offset:33792
    ds_read_b128 v[184:187], v33 offset:34816
    ds_read_b128 v[188:191], v33 offset:35840
    v_mul_u32_u24 v40, 144, v4
    v_lshl_add_u32 v40, v3, 3, v40
    s_add_u32 s18, s59, 49152
    v_add_u32 v40, s18, v40
    v_mul_u32_u24 v41, 144, v5
    v_and_b32 v42, 7, v2
    v_lshl_add_u32 v41, v42, 4, v41
    v_add_u32 v41, s18, v41
    s_waitcnt lgkmcnt(0)

    v_pk_add_f32 v[128:129], v[128:129], v[144:145]
    v_pk_add_f32 v[130:131], v[130:131], v[146:147]
    v_pk_add_f32 v[128:129], v[128:129], v[160:161]
    v_pk_add_f32 v[130:131], v[130:131], v[162:163]
    v_pk_add_f32 v[128:129], v[128:129], v[176:177]
    v_pk_add_f32 v[130:131], v[130:131], v[178:179]
    v_lshlrev_b32 v44, 16, v8
    v_and_b32 v45, s15, v8
    v_lshlrev_b32 v46, 16, v9
    v_and_b32 v47, s15, v9
    v_pk_fma_f32 v[128:129], v[128:129], v[6:7], v[44:45] op_sel_hi:[1,0,1]
    v_pk_fma_f32 v[130:131], v[130:131], v[6:7], v[46:47] op_sel_hi:[1,0,1]
    v_cvt_pk_bf16_f32 v48, v128, v129
    v_cvt_pk_bf16_f32 v49, v130, v131
    ds_write_b64 v40, v[48:49] offset:0
    v_pk_add_f32 v[132:133], v[132:133], v[148:149]
    v_pk_add_f32 v[134:135], v[134:135], v[150:151]
    v_pk_add_f32 v[132:133], v[132:133], v[164:165]
    v_pk_add_f32 v[134:135], v[134:135], v[166:167]
    v_pk_add_f32 v[132:133], v[132:133], v[180:181]
    v_pk_add_f32 v[134:135], v[134:135], v[182:183]
    v_lshlrev_b32 v44, 16, v10
    v_and_b32 v45, s15, v10
    v_lshlrev_b32 v46, 16, v11
    v_and_b32 v47, s15, v11
    v_pk_fma_f32 v[132:133], v[132:133], v[6:7], v[44:45] op_sel_hi:[1,0,1]
    v_pk_fma_f32 v[134:135], v[134:135], v[6:7], v[46:47] op_sel_hi:[1,0,1]
    v_cvt_pk_bf16_f32 v48, v132, v133
    v_cvt_pk_bf16_f32 v49, v134, v135
    ds_write_b64 v40, v[48:49] offset:32
    v_pk_add_f32 v[136:137], v[136:137], v[152:153]
    v_pk_add_f32 v[138:139], v[138:139], v[154:155]
    v_pk_add_f32 v[136:137], v[136:137], v[168:169]
    v_pk_add_f32 v[138:139], v[138:139], v[170:171]
    v_pk_add_f32 v[136:137], v[136:137], v[184:185]
    v_pk_add_f32 v[138:139], v[138:139], v[186:187]
    v_lshlrev_b32 v44, 16, v12
    v_and_b32 v45, s15, v12
    v_lshlrev_b32 v46, 16, v13
    v_and_b32 v47, s15, v13
    v_pk_fma_f32 v[136:137], v[136:137], v[6:7], v[44:45] op_sel_hi:[1,0,1]
    v_pk_fma_f32 v[138:139], v[138:139], v[6:7], v[46:47] op_sel_hi:[1,0,1]
    v_cvt_pk_bf16_f32 v48, v136, v137
    v_cvt_pk_bf16_f32 v49, v138, v139
    ds_write_b64 v40, v[48:49] offset:64
    v_pk_add_f32 v[140:141], v[140:141], v[156:157]
    v_pk_add_f32 v[142:143], v[142:143], v[158:159]
    v_pk_add_f32 v[140:141], v[140:141], v[172:173]
    v_pk_add_f32 v[142:143], v[142:143], v[174:175]
    v_pk_add_f32 v[140:141], v[140:141], v[188:189]
    v_pk_add_f32 v[142:143], v[142:143], v[190:191]
    v_lshlrev_b32 v44, 16, v14
    v_and_b32 v45, s15, v14
    v_lshlrev_b32 v46, 16, v15
    v_and_b32 v47, s15, v15
    v_pk_fma_f32 v[140:141], v[140:141], v[6:7], v[44:45] op_sel_hi:[1,0,1]
    v_pk_fma_f32 v[142:143], v[142:143], v[6:7], v[46:47] op_sel_hi:[1,0,1]
    v_cvt_pk_bf16_f32 v48, v140, v141
    v_cvt_pk_bf16_f32 v49, v142, v143
    ds_write_b64 v40, v[48:49] offset:96
    s_lshl_b32 s14, s12, 7
    s_lshl_b32 s17, s58, 4
    s_add_u32 s14, s14, s17
    s_mul_i32 s14, s14, 896
    s_lshl_b32 s17, s57, 7
    s_add_u32 s14, s14, s17
    s_add_u32 s17, s14, 7168
    s_mov_b32 s24, s50
    s_mov_b32 s25, s51
    s_mov_b32 s26, 1835008
    s_mov_b32 s27, 0x20000
    v_mul_u32_u24 v43, 896, v5
    v_lshl_add_u32 v43, v42, 4, v43
    s_waitcnt lgkmcnt(0)
    ds_read_b128 v[52:55], v41
    ds_read_b128 v[56:59], v41 offset:1152
    s_waitcnt lgkmcnt(1)
    buffer_store_dwordx4 v[52:55], v43, s[24:27], s14 offen
    s_waitcnt lgkmcnt(0)
    buffer_store_dwordx4 v[56:59], v43, s[24:27], s17 offen

    s_endpgm
k34_load:
    s_sub_u32 s3, s47, 4
    s_lshl_b32 s3, s3, 1
    v_lshrrev_b32 v5, 1, v4
    v_and_b32 v6, 1, v2
    s_lshl_b32 s14, s3, 11
    s_mul_i32 s15, s12, 114688
    s_add_u32 s14, s14, s15
    v_lshlrev_b32 v7, 8, v3
    v_lshl_add_u32 v7, v6, 4, v7
    v_add_u32 v7, s14, v7
    v_xor_b32 v27, v5, v3
    v_or_b32 v28, 4, v3
    v_xor_b32 v28, v5, v28
    v_lshl_add_u32 v20, v27, 5, v7
    v_lshl_add_u32 v21, v28, 5, v7
    s_lshl_b32 s14, s3, 3
    v_add_u32 v7, s14, v3
    s_movk_i32 s14, 3584
    v_mul_lo_u32 v7, v7, s14
    v_lshl_add_u32 v7, v6, 4, v7
    s_lshl_b32 s14, s13, 8
    v_add_u32 v7, s14, v7
    v_lshl_add_u32 v22, v27, 5, v7
    v_lshl_add_u32 v23, v28, 5, v7
    v_add_u32 v23, 13312, v23
    v_add_u32 v24, 26624, v22
    v_add_u32 v25, 26624, v23
    s_lshl_b32 s16, s3, 11
    s_add_u32 s16, s16, 114688
    s_mov_b32 s40, 0
    s_mov_b32 s41, 0
    s_lshl_b32 s42, s3, 11
    s_mov_b32 s44, 0
    s_waitcnt lgkmcnt(0)
    s_add_u32 s20, s8, 6291456
    s_addc_u32 s21, s9, 0
    s_mov_b32 s22, 1835008
    s_mov_b32 s23, 0x20000
    s_mov_b32 s24, s4
    s_mov_b32 s25, s5
    s_mov_b32 s26, 1605632
    s_mov_b32 s27, 0x20000
    s_mov_b32 s28, s6
    s_mov_b32 s29, s7
    s_mov_b32 s30, 1605632
    s_mov_b32 s31, 0x20000

    s_add_u32 s43, s16, s44
    s_mov_b32 m0, s43
    s_add_u32 s43, s43, 8192
    buffer_load_dwordx4 v22, s[24:27], s41 offen offset:0 lds
    buffer_load_dwordx4 v23, s[24:27], s41 offen offset:1024 lds
    buffer_load_dwordx4 v24, s[24:27], s41 offen offset:2048 lds
    buffer_load_dwordx4 v25, s[24:27], s41 offen offset:3072 lds
    s_mov_b32 m0, s43
    s_add_u32 s44, s44, 16384
    buffer_load_dwordx4 v22, s[28:31], s41 offen offset:0 lds
    buffer_load_dwordx4 v23, s[28:31], s41 offen offset:1024 lds
    buffer_load_dwordx4 v24, s[28:31], s41 offen offset:2048 lds
    buffer_load_dwordx4 v25, s[28:31], s41 offen offset:3072 lds
    s_mov_b32 m0, s42
    s_cmp_eq_u32 s44, 49152
    s_cselect_b32 s44, 0, s44
    buffer_load_dwordx4 v20, s[20:23], s40 offen offset:0 lds
    buffer_load_dwordx4 v21, s[20:23], s40 offen offset:1024 lds
    buffer_load_dwordx4 v20, s[20:23], s40 offen offset:2048 lds
    buffer_load_dwordx4 v21, s[20:23], s40 offen offset:3072 lds
    s_add_u32 s40, s40, 8192
    s_add_u32 s41, s41, 114688
    s_add_u32 s42, s42, 8192
    s_add_u32 s43, s16, s44
    s_mov_b32 m0, s43
    s_add_u32 s43, s43, 8192
    buffer_load_dwordx4 v22, s[24:27], s41 offen offset:0 lds
    buffer_load_dwordx4 v23, s[24:27], s41 offen offset:1024 lds
    buffer_load_dwordx4 v24, s[24:27], s41 offen offset:2048 lds
    buffer_load_dwordx4 v25, s[24:27], s41 offen offset:3072 lds
    s_mov_b32 m0, s43
    s_add_u32 s44, s44, 16384
    buffer_load_dwordx4 v22, s[28:31], s41 offen offset:0 lds
    buffer_load_dwordx4 v23, s[28:31], s41 offen offset:1024 lds
    buffer_load_dwordx4 v24, s[28:31], s41 offen offset:2048 lds
    buffer_load_dwordx4 v25, s[28:31], s41 offen offset:3072 lds
    s_mov_b32 m0, s42
    s_cmp_eq_u32 s44, 49152
    s_cselect_b32 s44, 0, s44
    buffer_load_dwordx4 v20, s[20:23], s40 offen offset:0 lds
    buffer_load_dwordx4 v21, s[20:23], s40 offen offset:1024 lds
    buffer_load_dwordx4 v20, s[20:23], s40 offen offset:2048 lds
    buffer_load_dwordx4 v21, s[20:23], s40 offen offset:3072 lds
    s_add_u32 s40, s40, 8192
    s_add_u32 s41, s41, 114688
    s_add_u32 s42, s42, 8192
    s_add_u32 s43, s16, s44
    s_mov_b32 m0, s43
    s_add_u32 s43, s43, 8192
    buffer_load_dwordx4 v22, s[24:27], s41 offen offset:0 lds
    buffer_load_dwordx4 v23, s[24:27], s41 offen offset:1024 lds
    buffer_load_dwordx4 v24, s[24:27], s41 offen offset:2048 lds
    buffer_load_dwordx4 v25, s[24:27], s41 offen offset:3072 lds
    s_mov_b32 m0, s43
    s_add_u32 s44, s44, 16384
    buffer_load_dwordx4 v22, s[28:31], s41 offen offset:0 lds
    buffer_load_dwordx4 v23, s[28:31], s41 offen offset:1024 lds
    buffer_load_dwordx4 v24, s[28:31], s41 offen offset:2048 lds
    buffer_load_dwordx4 v25, s[28:31], s41 offen offset:3072 lds
    s_mov_b32 m0, s42
    s_cmp_eq_u32 s44, 49152
    s_cselect_b32 s44, 0, s44
    buffer_load_dwordx4 v20, s[20:23], s40 offen offset:0 lds
    buffer_load_dwordx4 v21, s[20:23], s40 offen offset:1024 lds
    buffer_load_dwordx4 v20, s[20:23], s40 offen offset:2048 lds
    buffer_load_dwordx4 v21, s[20:23], s40 offen offset:3072 lds
    s_add_u32 s40, s40, 8192
    s_add_u32 s41, s41, 114688
    s_add_u32 s42, s42, 8192
    v_lshrrev_b32 v5, 3, v2
    v_mul_u32_u24 v32, 896, v5
    v_bfe_u32 v6, v2, 1, 2
    v_xor_b32 v6, v6, v3
    v_lshlrev_b32 v6, 5, v6
    v_and_b32 v36, 1, v2
    v_lshl_add_u32 v6, v36, 4, v6
    v_add_u32 v32, v32, v6
    s_lshr_b32 s57, s13, 1
    s_lshl_b32 s18, s57, 7
    v_add_u32 v32, s18, v32
    v_add_u32 v33, 6144, v32
    v_add_u32 v34, 12288, v32
    v_add_u32 v35, 18432, v32
    s_waitcnt vmcnt(24)
    s_barrier
    s_mov_b32 s46, 0
k34_aloop:
    s_cmp_lt_u32 s46, 12
    s_cbranch_scc1 k34_al_a
    s_waitcnt vmcnt(0)
k34_al_a:
    s_waitcnt vmcnt(12)
    s_barrier
    s_cmp_gt_u32 s46, 10
    s_cbranch_scc1 k34_al_b

    s_add_u32 s43, s16, s44
    s_mov_b32 m0, s43
    s_add_u32 s43, s43, 8192
    buffer_load_dwordx4 v22, s[24:27], s41 offen offset:0 lds
    buffer_load_dwordx4 v23, s[24:27], s41 offen offset:1024 lds
    buffer_load_dwordx4 v24, s[24:27], s41 offen offset:2048 lds
    buffer_load_dwordx4 v25, s[24:27], s41 offen offset:3072 lds
    s_mov_b32 m0, s43
    s_add_u32 s44, s44, 16384
    buffer_load_dwordx4 v22, s[28:31], s41 offen offset:0 lds
    buffer_load_dwordx4 v23, s[28:31], s41 offen offset:1024 lds
    buffer_load_dwordx4 v24, s[28:31], s41 offen offset:2048 lds
    buffer_load_dwordx4 v25, s[28:31], s41 offen offset:3072 lds
    s_mov_b32 m0, s42
    s_cmp_eq_u32 s44, 49152
    s_cselect_b32 s44, 0, s44
    buffer_load_dwordx4 v20, s[20:23], s40 offen offset:0 lds
    buffer_load_dwordx4 v21, s[20:23], s40 offen offset:1024 lds
    buffer_load_dwordx4 v20, s[20:23], s40 offen offset:2048 lds
    buffer_load_dwordx4 v21, s[20:23], s40 offen offset:3072 lds
    s_add_u32 s40, s40, 8192
    s_add_u32 s41, s41, 114688
    s_add_u32 s42, s42, 8192
k34_al_b:
    s_add_u32 s46, s46, 1
    s_cmp_lt_u32 s46, 14
    s_cbranch_scc1 k34_aloop
    s_mov_b32 s20, s48
    s_mov_b32 s21, s49
    s_mov_b32 s22, 1605632
    s_mov_b32 s23, 0x20000
    s_mul_i32 s40, s3, 401408
    s_add_u32 s41, s40, 401408
    s_lshl_b32 s42, s3, 12
    s_mov_b32 s46, 0
    s_barrier
    s_barrier
k34_wdloop:
    s_mov_b32 m0, s42
    s_add_u32 s43, s42, 4096

    buffer_load_dwordx4 v32, s[20:23], s40 offen offset:0 lds
    buffer_load_dwordx4 v33, s[20:23], s40 offen offset:1024 lds
    buffer_load_dwordx4 v34, s[20:23], s40 offen offset:2048 lds
    buffer_load_dwordx4 v35, s[20:23], s40 offen offset:3072 lds
    s_mov_b32 m0, s43
    s_add_u32 s40, s40, 28672
    buffer_load_dwordx4 v32, s[20:23], s41 offen offset:0 lds
    buffer_load_dwordx4 v33, s[20:23], s41 offen offset:1024 lds
    buffer_load_dwordx4 v34, s[20:23], s41 offen offset:2048 lds
    buffer_load_dwordx4 v35, s[20:23], s41 offen offset:3072 lds
    s_add_u32 s41, s41, 28672
    s_add_u32 s42, s42, 16384
    s_add_u32 s46, s46, 1
    s_cmp_eq_u32 s46, 10
    s_cbranch_scc0 k34_wd2
    s_waitcnt vmcnt(48)
    s_barrier
    s_barrier
    s_lshl_b32 s42, s3, 12
k34_wd2:
    s_cmp_lt_u32 s46, 14
    s_cbranch_scc1 k34_wdloop
    s_waitcnt vmcnt(32)
    s_barrier
    s_waitcnt vmcnt(0)
    s_barrier
    s_endpgm

k34_stats:
    v_lshrrev_b32 v7, 2, v2
    v_and_b32 v24, 7, v7
    s_and_b32 s14, s13, 7
    v_xor_b32 v24, s14, v24
    v_and_b32 v25, 3, v2
    v_lshlrev_b32 v26, 8, v7
    v_lshl_add_u32 v26, v25, 3, v26
    v_lshl_add_u32 v8, v24, 5, v26
    v_mov_b32 v64, 0
    v_mov_b32 v65, 0
    v_mov_b32 v66, 0
    v_mov_b32 v67, 0
    v_mov_b32 v68, 0
    v_mov_b32 v69, 0
    v_mov_b32 v70, 0
    v_mov_b32 v71, 0
    v_mov_b32 v72, 0x3f803f80
    v_mov_b32 v73, 0x3f803f80
    v_mov_b32 v74, 0x3f803f80
    v_mov_b32 v75, 0x3f803f80
    s_mov_b32 s15, 0xffff0000
    s_waitcnt lgkmcnt(0)
    s_mov_b32 s52, s8
    s_mov_b32 s53, s9
    s_mov_b32 s54, 0x1800000
    s_mov_b32 s55, 0x20000

    s_barrier
    ds_read_b64_tr_b16 v[32:33], v8 offset:0
    ds_read_b64_tr_b16 v[34:35], v8 offset:4096
    v_add_u32 v8, 8192, v8
    s_waitcnt lgkmcnt(0)
    v_mfma_f32_16x16x32_bf16 v[64:67], v[32:35], v[32:35], v[64:67]
    v_mfma_f32_16x16x32_bf16 v[68:71], v[72:75], v[32:35], v[68:71]
    s_mov_b32 s24, s48
    s_mov_b32 s25, s49
    s_mov_b32 s26, 1605632
    s_mov_b32 s27, 0x20000
    s_and_b32 s28, s12, 3
    s_mul_i32 s28, s28, 401408
    s_lshr_b32 s29, s13, 1
    s_lshl_b32 s29, s29, 7
    s_add_u32 s28, s28, s29
    v_mul_u32_u24 v80, 896, v2

    s_mov_b32 s46, 0
k34_sloop:
    s_barrier
    s_cmp_eq_u32 s46, 13
    s_cbranch_scc1 k34_sdone
    ds_read_b64_tr_b16 v[32:33], v8 offset:0
    ds_read_b64_tr_b16 v[34:35], v8 offset:4096
    v_add_u32 v8, 8192, v8
    s_waitcnt lgkmcnt(0)
    v_mfma_f32_16x16x32_bf16 v[64:67], v[32:35], v[32:35], v[64:67]
    v_mfma_f32_16x16x32_bf16 v[68:71], v[72:75], v[32:35], v[68:71]
    s_cmp_ge_u32 s46, 7
    s_cbranch_scc1 k34_notouch
    buffer_load_dword v81, v80, s[24:27], s28 offen
    s_add_u32 s28, s28, 57344
k34_notouch:
    s_add_u32 s46, s46, 1
    s_branch k34_sloop
k34_sdone:
    s_nop 7
    v_and_b32 v30, 3, v4
    v_cmp_eq_u32 vcc, 1, v30
    v_cmp_eq_u32 s[18:19], 2, v30
    v_cmp_eq_u32 s[20:21], 3, v30
    s_nop 1
    v_cndmask_b32 v25, v64, v65, vcc
    v_cndmask_b32 v25, v25, v66, s[18:19]
    v_cndmask_b32 v25, v25, v67, s[20:21]
    v_mov_b32 v24, v68
    v_mul_f32 v24, 0x3b124925, v24
    v_mul_f32 v25, 0x3b124925, v25
    v_fma_f32 v25, -v24, v24, v25
    v_max_f32 v25, 0, v25
    v_cvt_pk_bf16_f32 v25, v25, v25
    v_and_b32 v25, s15, v25
    v_add_f32 v25, 0x3727c5ac, v25
    v_cvt_pk_bf16_f32 v25, v25, v25
    v_and_b32 v25, s15, v25
    v_sqrt_f32 v25, v25
    s_nop 0
    v_cvt_pk_bf16_f32 v25, v25, v25
    v_and_b32 v25, s15, v25
    v_rcp_f32 v25, v25
    s_nop 0
    v_mul_f32 v25, v25, v25
    s_cmp_ge_u32 s13, 8
    s_cbranch_scc1 k34_nors
    s_lshl_b32 s14, s12, 9
    s_lshl_b32 s17, s13, 6
    s_add_u32 s14, s14, s17
    s_add_u32 s14, s14, 8454144
    v_lshlrev_b32 v40, 2, v4
    v_lshrrev_b32 v30, 2, v4
    v_cmp_eq_u32 vcc, v30, v3
    s_and_saveexec_b64 s[18:19], vcc
    buffer_store_dword v25, v40, s[52:55], s14 offen sc1
    s_mov_b64 exec, s[18:19]
k34_nors:
    s_lshl_b32 s18, s12, 7
    s_add_u32 s18, s18, 36864
    v_mov_b32 v34, s18
    v_mov_b32 v35, 1
    s_barrier
    s_waitcnt vmcnt(0)
    s_mov_b64 exec, 1
    buffer_atomic_add v35, v34, s[52:55], 0 offen sc1
    s_mov_b64 exec, -1
    s_barrier
    s_barrier
    s_barrier
    s_mov_b64 exec, 1
    s_mov_b32 s44, 200000
k34_poll:
    buffer_load_dword v36, v34, s[52:55], 0 offen sc1
    s_waitcnt vmcnt(0)
    v_readfirstlane_b32 s18, v36
    s_sub_u32 s44, s44, 1
    s_nop 2
    s_cmp_ge_u32 s18, 70
    s_cbranch_scc1 k34_polled
    s_cmp_eq_u32 s44, 0
    s_cbranch_scc1 k34_polled
    s_sleep 2
    s_branch k34_poll
k34_polled:
    s_mov_b64 exec, -1
    s_barrier

k34_end:
    s_endpgm

.section .rodata,"a"
.p2align 6
.amdhsa_kernel k12_kernel
  .amdhsa_next_free_vgpr 168
  .amdhsa_next_free_sgpr 64
  .amdhsa_accum_offset 168
  .amdhsa_group_segment_fixed_size 0
  .amdhsa_kernarg_size 128
  .amdhsa_user_sgpr_count 2
  .amdhsa_user_sgpr_kernarg_segment_ptr 1
  .amdhsa_system_sgpr_workgroup_id_x 1
.end_amdhsa_kernel

.amdhsa_kernel k34_kernel
  .amdhsa_next_free_vgpr 256
  .amdhsa_next_free_sgpr 64
  .amdhsa_accum_offset 256
  .amdhsa_group_segment_fixed_size 0
  .amdhsa_kernarg_size 128
  .amdhsa_user_sgpr_count 2
  .amdhsa_user_sgpr_kernarg_segment_ptr 1
  .amdhsa_system_sgpr_workgroup_id_x 1
.end_amdhsa_kernel
```
